```python
import torch

def _softmax(x, axis=-1):
    return torch.softmax(x, dim=axis)
def _gelu(x):
    return torch.nn.functional.gelu(x, approximate="tanh")
def _silu(x):
    return torch.nn.functional.silu(x)
def _sigmoid(x):
    return torch.sigmoid(x)
def _layernorm(x, axis=-1, eps=1e-5):
    m = x.mean(dim=axis, keepdim=True)
    v = x.var(dim=axis, keepdim=True, unbiased=False)
    return (x - m) / torch.sqrt(v + eps)
def _scatter_add(tgt, idx, src, axis=0):
    return tgt.clone().index_add_(axis, idx, src)
def _segment_sum(src, seg, n):
    out = torch.zeros((n,) + src.shape[1:], dtype=src.dtype)
    return out.index_add_(0, seg, src)
def _pad(x, pw):
    flat = tuple(v for pair in reversed(pw) for v in pair)
    return torch.nn.functional.pad(x, flat)

kernel_name = 'gated_mix__linear_attn_block__dense_activation_gelu__prompt'

def setup_inputs():

    _w = (lambda a: (lambda t: t.to(torch.bfloat16) if t.is_floating_point() else t)(torch.as_tensor(a)))
    def _A_setup():
        B, S, D = 1, 2048, 640
        return {
            "x": _w((lambda *s: torch.randn(*s, dtype=torch.bfloat16) * 0.05)(B, S, D)),
            "wqkv": _w((lambda *s: torch.randn(*s, dtype=torch.bfloat16) * 0.8)(D, 3 * D)),
            "wo": _w((lambda *s: torch.randn(*s, dtype=torch.bfloat16) * 0.05)(D, D)),
        }
    _A_in = _A_setup()

    def _B_setup():
        B, S, D, F = 1, 2048, 640, 1728
        return {
            "x": _w((lambda *s: torch.randn(*s, dtype=torch.bfloat16) * 0.05)(B, S, D)),
            "w1": _w((lambda *s: torch.randn(*s, dtype=torch.bfloat16) * 3.2)(D, F) * (D ** -0.5)),
            "b1": _w((lambda *s: torch.randn(*s, dtype=torch.bfloat16) * 3.2)(F) * 0.01),
            "w2": _w((lambda *s: torch.randn(*s, dtype=torch.bfloat16) * 0.4)(F, D) * (F ** -0.5)),
            "b2": _w((lambda *s: torch.randn(*s, dtype=torch.bfloat16) * 0.8)(D) * 0.01),
        }
    _B_in = _B_setup()

    return {
        "A_x": _A_in["x"],
        "A_wqkv": _A_in["wqkv"],
        "A_wo": _A_in["wo"],
        "B_x": _B_in["x"],
        "B_w1": _B_in["w1"],
        "B_b1": _B_in["b1"],
        "B_w2": _B_in["w2"],
        "B_b2": _B_in["b2"],
        "gate_w": _w((lambda *s: torch.randn(*s, dtype=torch.bfloat16) * 0.05)(640) * 16.0),
    }

def reference(A_x, A_wqkv, A_wo, B_x, B_w1, B_b1, B_w2, B_b2, gate_w):
    def _A_ref(x, wqkv, wo):
        B, S, D = x.shape
        H = 32; Dh = D // H
        qkv = (lambda x, *d: x.permute(*d))((x @ wqkv).reshape(B, S, 3, H, Dh), 2, 0, 3, 1, 4)
        q, k, v = qkv[0], qkv[1], qkv[2]
        phi = lambda t: torch.where(t > 0, t + 1, torch.exp(t)) + 1e-6
        pq, pk = phi(q), phi(k)
        kv = torch.einsum("bhsd,bhse->bhde", pk, v)
        z = torch.einsum("bhsd->bhd", pk)
        num = torch.einsum("bhqd,bhde->bhqe", pq, kv)
        den = torch.einsum("bhqd,bhd->bhq", pq, z)[..., None] + 1e-6
        o = num / den
        return (lambda x, *d: x.permute(*d))(o, 0, 2, 1, 3).reshape(B, S, D) @ wo

    def _B_ref(x, w1, b1, w2, b2):
        h = torch.einsum("bsd,df->bsf", x, w1) + b1
        h = _gelu(h)
        return torch.einsum("bsf,fd->bsd", h, w2) + b2

    x = A_x
    g = _sigmoid((x * gate_w).sum(-1, keepdims=True))
    a = _A_ref(x, A_wqkv, A_wo)
    b = _B_ref(x, B_w1, B_b1, B_w2, B_b2)
    return g * a + (1 - g) * b
```

```asm
; @launch kernel=k1_gemm_kernel grid=(256,1,1) block=(512,1,1) lds=135168
; @launch kernel=k2_small_kernel grid=(256,1,1) block=(256,1,1) lds=37888
; @launch kernel=gated_mix__linear_attn_block__dense_activation_gelu__prompt_kernel grid=(256,1,1) block=(256,1,1) lds=147456
.amdgcn_target "amdgcn-amd-amdhsa--gfx950"
.text
.globl k1_gemm_kernel
.p2align 8
.type k1_gemm_kernel,@function
k1_gemm_kernel:
    s_cmp_ge_u32 s2, 256
    s_cbranch_scc1 K1_EXIT
    s_and_b32 s3, s2, 7
    s_lshl_b32 s3, s3, 5
    s_lshr_b32 s47, s2, 3
    s_add_u32 s3, s3, s47
    s_cmp_ge_u32 s3, 253
    s_cbranch_scc1 K1_EXIT
    s_load_dwordx4 s[36:39], s[0:1], 0
    s_load_dwordx4 s[40:43], s[0:1], 32
    s_load_dwordx2 s[44:45], s[0:1], 88
    s_cmp_lt_u32 s3, 138
    s_cbranch_scc0 K1_MAPB
    s_mul_i32 s5, s3, 171
    s_lshr_b32 s5, s5, 10
    s_mul_i32 s47, s5, 6
    s_sub_u32 s4, s3, s47
    s_branch K1_MAPD
K1_MAPB:
    s_sub_u32 s3, s3, 138
    s_mul_i32 s5, s3, 205
    s_lshr_b32 s5, s5, 10
    s_mul_i32 s47, s5, 5
    s_sub_u32 s4, s3, s47
    s_add_u32 s4, s4, 6
K1_MAPD:
    v_lshrrev_b32 v1, 6, v0
    v_and_b32 v2, 63, v0
    s_nop 0
    v_readfirstlane_b32 s7, v1
    v_lshrrev_b32 v3, 4, v2
    v_and_b32 v4, 15, v2
    s_waitcnt lgkmcnt(0)
    s_mov_b32 s8, s36
    s_and_b32 s9, s37, 0xffff
    s_mov_b32 s10, 2621440
    s_mov_b32 s11, 0x00020000
    s_cmp_lt_u32 s5, 8
    s_cbranch_scc1 K1_SET_KV
    s_cmp_lt_u32 s5, 12
    s_cbranch_scc1 K1_SET_Q
    s_mov_b32 s50, 2
    s_mov_b32 s12, s40
    s_and_b32 s13, s41, 0xffff
    s_mov_b32 s14, 2211840
    s_mov_b32 s15, 0x00020000
    s_mov_b32 s33, 3456
    s_sub_u32 s47, s5, 12
    s_mul_i32 s46, s47, 320
    s_add_u32 s48, s44, 0
    s_addc_u32 s49, s45, 0
    s_mov_b32 s16, s48
    s_and_b32 s17, s49, 0xffff
    s_mov_b32 s18, 7077888
    s_mov_b32 s19, 0x00020000
    s_branch K1_SET_DONE
K1_SET_Q:
    s_mov_b32 s50, 1
    s_mov_b32 s12, s38
    s_and_b32 s13, s39, 0xffff
    s_mov_b32 s14, 2457600
    s_mov_b32 s15, 0x00020000
    s_mov_b32 s33, 3840
    s_sub_u32 s47, s5, 8
    s_mul_i32 s46, s47, 320
    s_add_u32 s48, s44, 7077888
    s_addc_u32 s49, s45, 0
    s_mov_b32 s16, s48
    s_and_b32 s17, s49, 0xffff
    s_mov_b32 s18, 2621440
    s_mov_b32 s19, 0x00020000
    s_branch K1_SET_DONE
K1_SET_KV:
    s_mov_b32 s50, 0
    s_mov_b32 s12, s38
    s_and_b32 s13, s39, 0xffff
    s_mov_b32 s14, 2457600
    s_mov_b32 s15, 0x00020000
    s_mov_b32 s33, 3840
    s_mul_i32 s46, s5, 160
    s_add_u32 s48, s44, 13148160
    s_addc_u32 s49, s45, 0
    s_mov_b32 s16, s48
    s_and_b32 s17, s49, 0xffff
    s_mov_b32 s18, 591360
    s_mov_b32 s19, 0x00020000
K1_SET_DONE:
    s_mov_b32 s20, s42
    s_and_b32 s21, s43, 0xffff
    s_mov_b32 s22, 3456
    s_mov_b32 s23, 0x00020000
    s_lshl_b32 s26, s33, 6
    s_mov_b32 s24, 0
    s_mov_b32 s25, 0
    s_mul_i32 s27, s7, 3072
    s_add_u32 s28, s27, 1024
    s_add_u32 s29, s27, 2048
    s_lshl_b32 s30, s7, 10
    s_add_u32 s30, s30, 24576
    s_add_u32 s31, s30, 8192
    s_add_u32 s47, s30, 16384
    s_cmp_lt_u32 s7, 4
    s_cselect_b32 s32, s47, s31
    s_mul_i32 s47, s7, 24
    s_mul_i32 s48, s4, 192
    s_add_u32 s47, s47, s48
    v_lshrrev_b32 v1, 3, v2
    v_and_b32 v5, 7, v2
    v_xor_b32 v5, v5, v1
    v_lshlrev_b32 v5, 4, v5
    v_add_u32 v1, s47, v1
    s_movk_i32 s48, 1280
    v_mul_lo_u32 v1, v1, s48
    v_add_u32 v6, v1, v5
    v_add_u32 v7, 10240, v6
    v_add_u32 v8, 20480, v6
    s_mov_b32 s47, s7
    s_lshl_b32 s47, s47, 6
    v_add_u32 v1, s47, v2
    s_movk_i32 s48, 3277
    v_mul_lo_u32 v5, v1, s48
    v_lshrrev_b32 v5, 16, v5
    v_mul_u32_u24 v12, 20, v5
    v_sub_u32 v12, v1, v12
    v_lshrrev_b32 v13, 3, v5
    v_and_b32 v13, 1, v13
    v_lshlrev_b32 v13, 1, v13
    v_xor_b32 v12, v12, v13
    v_mul_lo_u32 v5, v5, s33
    v_lshlrev_b32 v13, 4, v12
    v_add_u32 v5, v5, v13
    v_add_u32 v5, s46, v5
    s_cmp_lg_u32 s50, 0
    s_cbranch_scc1 K1_WOFF_DONE0
    v_cmp_le_u32 vcc, 10, v12
    v_mov_b32 v13, 0
    v_mov_b32 v14, 10
    v_cndmask_b32 v13, v13, v14, vcc
    v_sub_u32 v14, v12, v13
    v_lshlrev_b32 v13, 3, v13
    v_sub_u32 v5, v5, v13
    v_cmp_le_u32 vcc, 5, v14
    v_mov_b32 v13, 1280
    v_mov_b32 v14, 2480
    v_cndmask_b32 v13, v13, v14, vcc
    v_add_u32 v5, v5, v13
K1_WOFF_DONE0:
    v_mov_b32 v9, v5
    s_add_u32 s47, s7, 8
    s_lshl_b32 s47, s47, 6
    v_add_u32 v1, s47, v2
    s_movk_i32 s48, 3277
    v_mul_lo_u32 v5, v1, s48
    v_lshrrev_b32 v5, 16, v5
    v_mul_u32_u24 v12, 20, v5
    v_sub_u32 v12, v1, v12
    v_lshrrev_b32 v13, 3, v5
    v_and_b32 v13, 1, v13
    v_lshlrev_b32 v13, 1, v13
    v_xor_b32 v12, v12, v13
    v_mul_lo_u32 v5, v5, s33
    v_lshlrev_b32 v13, 4, v12
    v_add_u32 v5, v5, v13
    v_add_u32 v5, s46, v5
    s_cmp_lg_u32 s50, 0
    s_cbranch_scc1 K1_WOFF_DONE1
    v_cmp_le_u32 vcc, 10, v12
    v_mov_b32 v13, 0
    v_mov_b32 v14, 10
    v_cndmask_b32 v13, v13, v14, vcc
    v_sub_u32 v14, v12, v13
    v_lshlrev_b32 v13, 3, v13
    v_sub_u32 v5, v5, v13
    v_cmp_le_u32 vcc, 5, v14
    v_mov_b32 v13, 1280
    v_mov_b32 v14, 2480
    v_cndmask_b32 v13, v13, v14, vcc
    v_add_u32 v5, v5, v13
K1_WOFF_DONE1:
    v_mov_b32 v10, v5
    s_add_u32 s47, s7, 16
    s_add_u32 s48, s7, 8
    s_cmp_lt_u32 s7, 4
    s_cselect_b32 s47, s47, s48
    s_lshl_b32 s47, s47, 6
    v_add_u32 v1, s47, v2
    s_movk_i32 s48, 3277
    v_mul_lo_u32 v5, v1, s48
    v_lshrrev_b32 v5, 16, v5
    v_mul_u32_u24 v12, 20, v5
    v_sub_u32 v12, v1, v12
    v_lshrrev_b32 v13, 3, v5
    v_and_b32 v13, 1, v13
    v_lshlrev_b32 v13, 1, v13
    v_xor_b32 v12, v12, v13
    v_mul_lo_u32 v5, v5, s33
    v_lshlrev_b32 v13, 4, v12
    v_add_u32 v5, v5, v13
    v_add_u32 v5, s46, v5
    s_cmp_lg_u32 s50, 0
    s_cbranch_scc1 K1_WOFF_DONE2
    v_cmp_le_u32 vcc, 10, v12
    v_mov_b32 v13, 0
    v_mov_b32 v14, 10
    v_cndmask_b32 v13, v13, v14, vcc
    v_sub_u32 v14, v12, v13
    v_lshlrev_b32 v13, 3, v13
    v_sub_u32 v5, v5, v13
    v_cmp_le_u32 vcc, 5, v14
    v_mov_b32 v13, 1280
    v_mov_b32 v14, 2480
    v_cndmask_b32 v13, v13, v14, vcc
    v_add_u32 v5, v5, v13
K1_WOFF_DONE2:
    v_mov_b32 v11, v5
    s_and_b32 s47, s7, 3
    s_lshr_b32 s48, s7, 2
    s_mul_i32 s49, s47, 48
    v_add_u32 v1, s49, v4
    v_lshlrev_b32 v1, 7, v1
    v_and_b32 v5, 7, v2
    v_xor_b32 v24, v3, v5
    v_lshlrev_b32 v24, 4, v24
    v_add_u32 v12, v1, v24
    v_xor_b32 v13, 64, v12
    v_lshlrev_b32 v1, 3, v3
    v_lshrrev_b32 v5, 2, v4
    v_add_u32 v1, v1, v5
    v_mul_u32_u24 v1, 320, v1
    v_and_b32 v5, 3, v2
    v_lshlrev_b32 v5, 3, v5
    v_add_u32 v1, v1, v5
    s_mul_i32 s49, s48, 160
    v_add_u32 v1, s49, v1
    v_and_b32 v5, 1, v3
    v_lshlrev_b32 v5, 5, v5
    v_add_u32 v24, v1, v5
    v_sub_u32 v25, v1, v5
    s_cmp_eq_u32 s48, 0
    s_cbranch_scc1 K1_NH0
    v_mov_b32 v14, v25
    v_mov_b32 v15, v24
    s_branch K1_NHD
K1_NH0:
    v_mov_b32 v14, v24
    v_mov_b32 v15, v25
K1_NHD:
    s_cmp_lg_u32 s50, 2
    s_cbranch_scc1 K1_NOB1
    s_mul_i32 s49, s48, 160
    s_add_u32 s49, s49, s46
    v_lshlrev_b32 v1, 3, v3
    v_add_u32 v1, s49, v1
    buffer_load_dwordx2 v[148:149], v1, s[20:23], 0 offen offset:0
    buffer_load_dwordx2 v[150:151], v1, s[20:23], 0 offen offset:32
    buffer_load_dwordx2 v[152:153], v1, s[20:23], 0 offen offset:64
    buffer_load_dwordx2 v[154:155], v1, s[20:23], 0 offen offset:96
    buffer_load_dwordx2 v[156:157], v1, s[20:23], 0 offen offset:128
K1_NOB1:
    v_mov_b32 v88, 0
    v_mov_b32 v89, 0
    v_mov_b32 v90, 0
    v_mov_b32 v91, 0
    v_mov_b32 v92, 0
    v_mov_b32 v93, 0
    v_mov_b32 v94, 0
    v_mov_b32 v95, 0
    v_mov_b32 v96, 0
    v_mov_b32 v97, 0
    v_mov_b32 v98, 0
    v_mov_b32 v99, 0
    v_mov_b32 v100, 0
    v_mov_b32 v101, 0
    v_mov_b32 v102, 0
    v_mov_b32 v103, 0
    v_mov_b32 v104, 0
    v_mov_b32 v105, 0
    v_mov_b32 v106, 0
    v_mov_b32 v107, 0
    v_mov_b32 v108, 0
    v_mov_b32 v109, 0
    v_mov_b32 v110, 0
    v_mov_b32 v111, 0
    v_mov_b32 v112, 0
    v_mov_b32 v113, 0
    v_mov_b32 v114, 0
    v_mov_b32 v115, 0
    v_mov_b32 v116, 0
    v_mov_b32 v117, 0
    v_mov_b32 v118, 0
    v_mov_b32 v119, 0
    v_mov_b32 v120, 0
    v_mov_b32 v121, 0
    v_mov_b32 v122, 0
    v_mov_b32 v123, 0
    v_mov_b32 v124, 0
    v_mov_b32 v125, 0
    v_mov_b32 v126, 0
    v_mov_b32 v127, 0
    v_mov_b32 v128, 0
    v_mov_b32 v129, 0
    v_mov_b32 v130, 0
    v_mov_b32 v131, 0
    v_mov_b32 v132, 0
    v_mov_b32 v133, 0
    v_mov_b32 v134, 0
    v_mov_b32 v135, 0
    v_mov_b32 v136, 0
    v_mov_b32 v137, 0
    v_mov_b32 v138, 0
    v_mov_b32 v139, 0
    v_mov_b32 v140, 0
    v_mov_b32 v141, 0
    v_mov_b32 v142, 0
    v_mov_b32 v143, 0
    v_mov_b32 v144, 0
    v_mov_b32 v145, 0
    v_mov_b32 v146, 0
    v_mov_b32 v147, 0
    s_mov_b32 s59, 0
    s_cmp_eq_u32 s50, 0
    s_cbranch_scc1 K1_KV
    s_mov_b32 s55, 0
    s_add_u32 s96, s27, s55
    s_add_u32 s99, s30, s55
    s_add_u32 s97, s28, s55
    s_add_u32 s100, s31, s55
    s_add_u32 s98, s29, s55
    s_add_u32 s101, s32, s55
    s_mov_b32 m0, s96
    s_nop 0
    buffer_load_dwordx4 v6, s[8:11], s24 offen lds
    s_mov_b32 m0, s97
    s_nop 0
    buffer_load_dwordx4 v7, s[8:11], s24 offen lds
    s_mov_b32 m0, s98
    s_nop 0
    buffer_load_dwordx4 v8, s[8:11], s24 offen lds
    s_mov_b32 m0, s99
    s_nop 0
    buffer_load_dwordx4 v9, s[12:15], s25 offen lds
    s_mov_b32 m0, s100
    s_nop 0
    buffer_load_dwordx4 v10, s[12:15], s25 offen lds
    s_mov_b32 m0, s101
    s_nop 0
    buffer_load_dwordx4 v11, s[12:15], s25 offen lds
    s_add_u32 s24, s24, 128
    s_add_u32 s25, s25, s26
    s_add_u32 s55, s55, 45056
    s_cmp_eq_u32 s55, 135168
    s_cselect_b32 s55, 0, s55
    s_add_u32 s96, s27, s55
    s_add_u32 s99, s30, s55
    s_add_u32 s97, s28, s55
    s_add_u32 s100, s31, s55
    s_add_u32 s98, s29, s55
    s_add_u32 s101, s32, s55
    s_mov_b32 m0, s96
    s_nop 0
    buffer_load_dwordx4 v6, s[8:11], s24 offen lds
    s_mov_b32 m0, s97
    s_nop 0
    buffer_load_dwordx4 v7, s[8:11], s24 offen lds
    s_mov_b32 m0, s98
    s_nop 0
    buffer_load_dwordx4 v8, s[8:11], s24 offen lds
    s_mov_b32 m0, s99
    s_nop 0
    buffer_load_dwordx4 v9, s[12:15], s25 offen lds
    s_mov_b32 m0, s100
    s_nop 0
    buffer_load_dwordx4 v10, s[12:15], s25 offen lds
    s_mov_b32 m0, s101
    s_nop 0
    buffer_load_dwordx4 v11, s[12:15], s25 offen lds
    s_add_u32 s24, s24, 128
    s_add_u32 s25, s25, s26
    s_add_u32 s55, s55, 45056
    s_cmp_eq_u32 s55, 135168
    s_cselect_b32 s55, 0, s55
    s_add_u32 s96, s27, s55
    s_add_u32 s99, s30, s55
    s_add_u32 s97, s28, s55
    s_add_u32 s100, s31, s55
    s_add_u32 s98, s29, s55
    s_add_u32 s101, s32, s55
    s_mov_b32 m0, s96
    s_nop 0
    buffer_load_dwordx4 v6, s[8:11], s24 offen lds
    s_mov_b32 m0, s97
    s_nop 0
    buffer_load_dwordx4 v7, s[8:11], s24 offen lds
    s_mov_b32 m0, s98
    s_nop 0
    buffer_load_dwordx4 v8, s[8:11], s24 offen lds
    s_waitcnt vmcnt(9)
    s_barrier
    ds_read_b128 v[24:27], v12 offset:0
    ds_read_b128 v[28:31], v12 offset:2048
    ds_read_b128 v[32:35], v12 offset:4096
    ds_read_b64_tr_b16 v[36:37], v14 offset:24576
    ds_read_b64_tr_b16 v[38:39], v14 offset:25856
    ds_read_b64_tr_b16 v[40:41], v15 offset:24608
    ds_read_b64_tr_b16 v[42:43], v15 offset:25888
    ds_read_b64_tr_b16 v[44:45], v14 offset:24640
    ds_read_b64_tr_b16 v[46:47], v14 offset:25920
    ds_read_b64_tr_b16 v[48:49], v15 offset:24672
    ds_read_b64_tr_b16 v[50:51], v15 offset:25952
    ds_read_b64_tr_b16 v[52:53], v14 offset:24704
    ds_read_b64_tr_b16 v[54:55], v14 offset:25984
    s_mov_b32 s54, 0
K1_LOOP_qh:
    s_waitcnt lgkmcnt(0)
    s_cmp_lt_u32 s54, 8
    v_mfma_f32_16x16x32_bf16 v[88:91], v[36:39], v[24:27], v[88:91]
    ds_read_b128 v[56:59], v13 offset:0
    v_mfma_f32_16x16x32_bf16 v[108:111], v[36:39], v[28:31], v[108:111]
    ds_read_b128 v[60:63], v13 offset:2048
    v_mfma_f32_16x16x32_bf16 v[128:131], v[36:39], v[32:35], v[128:131]
    ds_read_b128 v[64:67], v13 offset:4096
    s_cbranch_scc0 K1Aqh_3
    s_mov_b32 m0, s99
    s_nop 0
    buffer_load_dwordx4 v9, s[12:15], s25 offen lds
K1Aqh_3:
    v_mfma_f32_16x16x32_bf16 v[92:95], v[40:43], v[24:27], v[92:95]
    ds_read_b64_tr_b16 v[68:69], v14 offset:34816
    v_mfma_f32_16x16x32_bf16 v[112:115], v[40:43], v[28:31], v[112:115]
    ds_read_b64_tr_b16 v[70:71], v14 offset:36096
    v_mfma_f32_16x16x32_bf16 v[132:135], v[40:43], v[32:35], v[132:135]
    ds_read_b64_tr_b16 v[72:73], v15 offset:34848
    v_mfma_f32_16x16x32_bf16 v[96:99], v[44:47], v[24:27], v[96:99]
    ds_read_b64_tr_b16 v[74:75], v15 offset:36128
    v_mfma_f32_16x16x32_bf16 v[116:119], v[44:47], v[28:31], v[116:119]
    ds_read_b64_tr_b16 v[76:77], v14 offset:34880
    s_cbranch_scc0 K1Aqh_4
    s_mov_b32 m0, s100
    s_nop 0
    buffer_load_dwordx4 v10, s[12:15], s25 offen lds
K1Aqh_4:
    v_mfma_f32_16x16x32_bf16 v[136:139], v[44:47], v[32:35], v[136:139]
    ds_read_b64_tr_b16 v[78:79], v14 offset:36160
    v_mfma_f32_16x16x32_bf16 v[100:103], v[48:51], v[24:27], v[100:103]
    ds_read_b64_tr_b16 v[80:81], v15 offset:34912
    v_mfma_f32_16x16x32_bf16 v[120:123], v[48:51], v[28:31], v[120:123]
    ds_read_b64_tr_b16 v[82:83], v15 offset:36192
    v_mfma_f32_16x16x32_bf16 v[140:143], v[48:51], v[32:35], v[140:143]
    ds_read_b64_tr_b16 v[84:85], v14 offset:34944
    v_mfma_f32_16x16x32_bf16 v[104:107], v[52:55], v[24:27], v[104:107]
    ds_read_b64_tr_b16 v[86:87], v14 offset:36224
    s_cbranch_scc0 K1Aqh_5
    s_mov_b32 m0, s101
    s_nop 0
    buffer_load_dwordx4 v11, s[12:15], s25 offen lds
K1Aqh_5:
    v_mfma_f32_16x16x32_bf16 v[124:127], v[52:55], v[28:31], v[124:127]
    v_mfma_f32_16x16x32_bf16 v[144:147], v[52:55], v[32:35], v[144:147]
    s_cbranch_scc0 K1_NOADV_qh
    s_add_u32 s24, s24, 128
    s_add_u32 s25, s25, s26
    s_add_u32 s55, s55, 45056
    s_cmp_eq_u32 s55, 135168
    s_cselect_b32 s55, 0, s55
    s_add_u32 s96, s27, s55
    s_add_u32 s99, s30, s55
    s_add_u32 s97, s28, s55
    s_add_u32 s100, s31, s55
    s_add_u32 s98, s29, s55
    s_add_u32 s101, s32, s55
K1_NOADV_qh:
    s_waitcnt lgkmcnt(0)
    s_cmp_eq_u32 s54, 9
    s_cbranch_scc1 K1_LAST_qh
    s_cmp_lt_u32 s54, 8
    s_cbranch_scc1 K1_W6_qh
    s_waitcnt vmcnt(0)
K1_W6_qh:
    s_waitcnt vmcnt(6)
    s_barrier
    s_add_u32 s59, s59, 1
    s_cmp_eq_u32 s59, 3
    s_cselect_b32 s59, 0, s59
    s_mov_b32 s47, 45056
    s_cselect_b32 s47, 4294877184, s47
    v_add_u32 v12, s47, v12
    v_add_u32 v13, s47, v13
    v_add_u32 v14, s47, v14
    v_add_u32 v15, s47, v15
    s_cmp_lt_u32 s54, 7
    v_mfma_f32_16x16x32_bf16 v[88:91], v[68:71], v[56:59], v[88:91]
    ds_read_b128 v[24:27], v12 offset:0
    v_mfma_f32_16x16x32_bf16 v[108:111], v[68:71], v[60:63], v[108:111]
    ds_read_b128 v[28:31], v12 offset:2048
    v_mfma_f32_16x16x32_bf16 v[128:131], v[68:71], v[64:67], v[128:131]
    ds_read_b128 v[32:35], v12 offset:4096
    s_cbranch_scc0 K1Bqh_0
    s_mov_b32 m0, s96
    s_nop 0
    buffer_load_dwordx4 v6, s[8:11], s24 offen lds
K1Bqh_0:
    v_mfma_f32_16x16x32_bf16 v[92:95], v[72:75], v[56:59], v[92:95]
    ds_read_b64_tr_b16 v[36:37], v14 offset:24576
    v_mfma_f32_16x16x32_bf16 v[112:115], v[72:75], v[60:63], v[112:115]
    ds_read_b64_tr_b16 v[38:39], v14 offset:25856
    v_mfma_f32_16x16x32_bf16 v[132:135], v[72:75], v[64:67], v[132:135]
    ds_read_b64_tr_b16 v[40:41], v15 offset:24608
    v_mfma_f32_16x16x32_bf16 v[96:99], v[76:79], v[56:59], v[96:99]
    ds_read_b64_tr_b16 v[42:43], v15 offset:25888
    v_mfma_f32_16x16x32_bf16 v[116:119], v[76:79], v[60:63], v[116:119]
    ds_read_b64_tr_b16 v[44:45], v14 offset:24640
    s_cbranch_scc0 K1Bqh_1
    s_mov_b32 m0, s97
    s_nop 0
    buffer_load_dwordx4 v7, s[8:11], s24 offen lds
K1Bqh_1:
    v_mfma_f32_16x16x32_bf16 v[136:139], v[76:79], v[64:67], v[136:139]
    ds_read_b64_tr_b16 v[46:47], v14 offset:25920
    v_mfma_f32_16x16x32_bf16 v[100:103], v[80:83], v[56:59], v[100:103]
    ds_read_b64_tr_b16 v[48:49], v15 offset:24672
    v_mfma_f32_16x16x32_bf16 v[120:123], v[80:83], v[60:63], v[120:123]
    ds_read_b64_tr_b16 v[50:51], v15 offset:25952
    v_mfma_f32_16x16x32_bf16 v[140:143], v[80:83], v[64:67], v[140:143]
    ds_read_b64_tr_b16 v[52:53], v14 offset:24704
    v_mfma_f32_16x16x32_bf16 v[104:107], v[84:87], v[56:59], v[104:107]
    ds_read_b64_tr_b16 v[54:55], v14 offset:25984
    s_cbranch_scc0 K1Bqh_2
    s_mov_b32 m0, s98
    s_nop 0
    buffer_load_dwordx4 v8, s[8:11], s24 offen lds
K1Bqh_2:
    v_mfma_f32_16x16x32_bf16 v[124:127], v[84:87], v[60:63], v[124:127]
    v_mfma_f32_16x16x32_bf16 v[144:147], v[84:87], v[64:67], v[144:147]
    s_add_u32 s54, s54, 1
    s_branch K1_LOOP_qh
K1_LAST_qh:
    v_mfma_f32_16x16x32_bf16 v[88:91], v[68:71], v[56:59], v[88:91]
    v_mfma_f32_16x16x32_bf16 v[108:111], v[68:71], v[60:63], v[108:111]
    v_mfma_f32_16x16x32_bf16 v[128:131], v[68:71], v[64:67], v[128:131]
    v_mfma_f32_16x16x32_bf16 v[92:95], v[72:75], v[56:59], v[92:95]
    v_mfma_f32_16x16x32_bf16 v[112:115], v[72:75], v[60:63], v[112:115]
    v_mfma_f32_16x16x32_bf16 v[132:135], v[72:75], v[64:67], v[132:135]
    v_mfma_f32_16x16x32_bf16 v[96:99], v[76:79], v[56:59], v[96:99]
    v_mfma_f32_16x16x32_bf16 v[116:119], v[76:79], v[60:63], v[116:119]
    v_mfma_f32_16x16x32_bf16 v[136:139], v[76:79], v[64:67], v[136:139]
    v_mfma_f32_16x16x32_bf16 v[100:103], v[80:83], v[56:59], v[100:103]
    v_mfma_f32_16x16x32_bf16 v[120:123], v[80:83], v[60:63], v[120:123]
    v_mfma_f32_16x16x32_bf16 v[140:143], v[80:83], v[64:67], v[140:143]
    v_mfma_f32_16x16x32_bf16 v[104:107], v[84:87], v[56:59], v[104:107]
    v_mfma_f32_16x16x32_bf16 v[124:127], v[84:87], v[60:63], v[124:127]
    v_mfma_f32_16x16x32_bf16 v[144:147], v[84:87], v[64:67], v[144:147]
    s_nop 7
    s_nop 7
    s_barrier
    s_and_b32 s47, s7, 3
    s_lshr_b32 s48, s7, 2
    s_mov_b32 s54, s47
    s_mov_b32 s55, s48
    s_mov_b32 s58, 0
    s_cmp_eq_u32 s50, 2
    s_cbranch_scc1 K1_EPI_H
    s_mul_i32 s49, s47, 48
    v_add_u32 v1, s49, v4
    v_mul_u32_u24 v1, 336, v1
    s_mul_i32 s49, s48, 160
    v_lshlrev_b32 v5, 3, v3
    v_add_u32 v1, v1, v5
    v_add_u32 v1, s49, v1
    s_mov_b32 s96, 1069066811
    s_mov_b32 s97, 1069066811
    s_mov_b32 s98, 897988541
    s_mov_b32 s99, 897988541
    v_min_f32 v24, 0, v88
    v_min_f32 v25, 0, v89
    v_min_f32 v26, 0, v90
    v_min_f32 v27, 0, v91
    v_min_f32 v28, 0, v92
    v_min_f32 v29, 0, v93
    v_min_f32 v30, 0, v94
    v_min_f32 v31, 0, v95
    v_min_f32 v32, 0, v96
    v_min_f32 v33, 0, v97
    v_min_f32 v34, 0, v98
    v_min_f32 v35, 0, v99
    v_min_f32 v36, 0, v100
    v_min_f32 v37, 0, v101
    v_min_f32 v38, 0, v102
    v_min_f32 v39, 0, v103
    v_min_f32 v40, 0, v104
    v_min_f32 v41, 0, v105
    v_min_f32 v42, 0, v106
    v_min_f32 v43, 0, v107
    v_pk_mul_f32 v[24:25], v[24:25], s[96:97]
    v_pk_mul_f32 v[26:27], v[26:27], s[96:97]
    v_pk_mul_f32 v[28:29], v[28:29], s[96:97]
    v_pk_mul_f32 v[30:31], v[30:31], s[96:97]
    v_pk_mul_f32 v[32:33], v[32:33], s[96:97]
    v_pk_mul_f32 v[34:35], v[34:35], s[96:97]
    v_pk_mul_f32 v[36:37], v[36:37], s[96:97]
    v_pk_mul_f32 v[38:39], v[38:39], s[96:97]
    v_pk_mul_f32 v[40:41], v[40:41], s[96:97]
    v_pk_mul_f32 v[42:43], v[42:43], s[96:97]
    v_exp_f32 v24, v24
    v_exp_f32 v25, v25
    v_exp_f32 v26, v26
    v_exp_f32 v27, v27
    v_exp_f32 v28, v28
    v_exp_f32 v29, v29
    v_exp_f32 v30, v30
    v_exp_f32 v31, v31
    v_exp_f32 v32, v32
    v_exp_f32 v33, v33
    v_exp_f32 v34, v34
    v_exp_f32 v35, v35
    v_exp_f32 v36, v36
    v_exp_f32 v37, v37
    v_exp_f32 v38, v38
    v_exp_f32 v39, v39
    v_exp_f32 v40, v40
    v_exp_f32 v41, v41
    v_exp_f32 v42, v42
    v_exp_f32 v43, v43
    v_max_f32 v44, 0, v88
    v_max_f32 v45, 0, v89
    v_max_f32 v46, 0, v90
    v_max_f32 v47, 0, v91
    v_max_f32 v48, 0, v92
    v_max_f32 v49, 0, v93
    v_max_f32 v50, 0, v94
    v_max_f32 v51, 0, v95
    v_max_f32 v52, 0, v96
    v_max_f32 v53, 0, v97
    v_max_f32 v54, 0, v98
    v_max_f32 v55, 0, v99
    v_max_f32 v56, 0, v100
    v_max_f32 v57, 0, v101
    v_max_f32 v58, 0, v102
    v_max_f32 v59, 0, v103
    v_max_f32 v60, 0, v104
    v_max_f32 v61, 0, v105
    v_max_f32 v62, 0, v106
    v_max_f32 v63, 0, v107
    v_pk_add_f32 v[44:45], v[44:45], s[98:99]
    v_pk_add_f32 v[46:47], v[46:47], s[98:99]
    v_pk_add_f32 v[48:49], v[48:49], s[98:99]
    v_pk_add_f32 v[50:51], v[50:51], s[98:99]
    v_pk_add_f32 v[52:53], v[52:53], s[98:99]
    v_pk_add_f32 v[54:55], v[54:55], s[98:99]
    v_pk_add_f32 v[56:57], v[56:57], s[98:99]
    v_pk_add_f32 v[58:59], v[58:59], s[98:99]
    v_pk_add_f32 v[60:61], v[60:61], s[98:99]
    v_pk_add_f32 v[62:63], v[62:63], s[98:99]
    v_pk_add_f32 v[24:25], v[24:25], v[44:45]
    v_pk_add_f32 v[26:27], v[26:27], v[46:47]
    v_pk_add_f32 v[28:29], v[28:29], v[48:49]
    v_pk_add_f32 v[30:31], v[30:31], v[50:51]
    v_pk_add_f32 v[32:33], v[32:33], v[52:53]
    v_pk_add_f32 v[34:35], v[34:35], v[54:55]
    v_pk_add_f32 v[36:37], v[36:37], v[56:57]
    v_pk_add_f32 v[38:39], v[38:39], v[58:59]
    v_pk_add_f32 v[40:41], v[40:41], v[60:61]
    v_pk_add_f32 v[42:43], v[42:43], v[62:63]
    v_cvt_pk_bf16_f32 v64, v24, v25
    v_cvt_pk_bf16_f32 v65, v26, v27
    v_cvt_pk_bf16_f32 v66, v28, v29
    v_cvt_pk_bf16_f32 v67, v30, v31
    v_cvt_pk_bf16_f32 v68, v32, v33
    v_cvt_pk_bf16_f32 v69, v34, v35
    v_cvt_pk_bf16_f32 v70, v36, v37
    v_cvt_pk_bf16_f32 v71, v38, v39
    v_cvt_pk_bf16_f32 v72, v40, v41
    v_cvt_pk_bf16_f32 v73, v42, v43
    ds_write_b64 v1, v[64:65] offset:0
    ds_write_b64 v1, v[66:67] offset:32
    ds_write_b64 v1, v[68:69] offset:64
    ds_write_b64 v1, v[70:71] offset:96
    ds_write_b64 v1, v[72:73] offset:128
    v_min_f32 v24, 0, v108
    v_min_f32 v25, 0, v109
    v_min_f32 v26, 0, v110
    v_min_f32 v27, 0, v111
    v_min_f32 v28, 0, v112
    v_min_f32 v29, 0, v113
    v_min_f32 v30, 0, v114
    v_min_f32 v31, 0, v115
    v_min_f32 v32, 0, v116
    v_min_f32 v33, 0, v117
    v_min_f32 v34, 0, v118
    v_min_f32 v35, 0, v119
    v_min_f32 v36, 0, v120
    v_min_f32 v37, 0, v121
    v_min_f32 v38, 0, v122
    v_min_f32 v39, 0, v123
    v_min_f32 v40, 0, v124
    v_min_f32 v41, 0, v125
    v_min_f32 v42, 0, v126
    v_min_f32 v43, 0, v127
    v_pk_mul_f32 v[24:25], v[24:25], s[96:97]
    v_pk_mul_f32 v[26:27], v[26:27], s[96:97]
    v_pk_mul_f32 v[28:29], v[28:29], s[96:97]
    v_pk_mul_f32 v[30:31], v[30:31], s[96:97]
    v_pk_mul_f32 v[32:33], v[32:33], s[96:97]
    v_pk_mul_f32 v[34:35], v[34:35], s[96:97]
    v_pk_mul_f32 v[36:37], v[36:37], s[96:97]
    v_pk_mul_f32 v[38:39], v[38:39], s[96:97]
    v_pk_mul_f32 v[40:41], v[40:41], s[96:97]
    v_pk_mul_f32 v[42:43], v[42:43], s[96:97]
    v_exp_f32 v24, v24
    v_exp_f32 v25, v25
    v_exp_f32 v26, v26
    v_exp_f32 v27, v27
    v_exp_f32 v28, v28
    v_exp_f32 v29, v29
    v_exp_f32 v30, v30
    v_exp_f32 v31, v31
    v_exp_f32 v32, v32
    v_exp_f32 v33, v33
    v_exp_f32 v34, v34
    v_exp_f32 v35, v35
    v_exp_f32 v36, v36
    v_exp_f32 v37, v37
    v_exp_f32 v38, v38
    v_exp_f32 v39, v39
    v_exp_f32 v40, v40
    v_exp_f32 v41, v41
    v_exp_f32 v42, v42
    v_exp_f32 v43, v43
    v_max_f32 v44, 0, v108
    v_max_f32 v45, 0, v109
    v_max_f32 v46, 0, v110
    v_max_f32 v47, 0, v111
    v_max_f32 v48, 0, v112
    v_max_f32 v49, 0, v113
    v_max_f32 v50, 0, v114
    v_max_f32 v51, 0, v115
    v_max_f32 v52, 0, v116
    v_max_f32 v53, 0, v117
    v_max_f32 v54, 0, v118
    v_max_f32 v55, 0, v119
    v_max_f32 v56, 0, v120
    v_max_f32 v57, 0, v121
    v_max_f32 v58, 0, v122
    v_max_f32 v59, 0, v123
    v_max_f32 v60, 0, v124
    v_max_f32 v61, 0, v125
    v_max_f32 v62, 0, v126
    v_max_f32 v63, 0, v127
    v_pk_add_f32 v[44:45], v[44:45], s[98:99]
    v_pk_add_f32 v[46:47], v[46:47], s[98:99]
    v_pk_add_f32 v[48:49], v[48:49], s[98:99]
    v_pk_add_f32 v[50:51], v[50:51], s[98:99]
    v_pk_add_f32 v[52:53], v[52:53], s[98:99]
    v_pk_add_f32 v[54:55], v[54:55], s[98:99]
    v_pk_add_f32 v[56:57], v[56:57], s[98:99]
    v_pk_add_f32 v[58:59], v[58:59], s[98:99]
    v_pk_add_f32 v[60:61], v[60:61], s[98:99]
    v_pk_add_f32 v[62:63], v[62:63], s[98:99]
    v_pk_add_f32 v[24:25], v[24:25], v[44:45]
    v_pk_add_f32 v[26:27], v[26:27], v[46:47]
    v_pk_add_f32 v[28:29], v[28:29], v[48:49]
    v_pk_add_f32 v[30:31], v[30:31], v[50:51]
    v_pk_add_f32 v[32:33], v[32:33], v[52:53]
    v_pk_add_f32 v[34:35], v[34:35], v[54:55]
    v_pk_add_f32 v[36:37], v[36:37], v[56:57]
    v_pk_add_f32 v[38:39], v[38:39], v[58:59]
    v_pk_add_f32 v[40:41], v[40:41], v[60:61]
    v_pk_add_f32 v[42:43], v[42:43], v[62:63]
    v_cvt_pk_bf16_f32 v64, v24, v25
    v_cvt_pk_bf16_f32 v65, v26, v27
    v_cvt_pk_bf16_f32 v66, v28, v29
    v_cvt_pk_bf16_f32 v67, v30, v31
    v_cvt_pk_bf16_f32 v68, v32, v33
    v_cvt_pk_bf16_f32 v69, v34, v35
    v_cvt_pk_bf16_f32 v70, v36, v37
    v_cvt_pk_bf16_f32 v71, v38, v39
    v_cvt_pk_bf16_f32 v72, v40, v41
    v_cvt_pk_bf16_f32 v73, v42, v43
    ds_write_b64 v1, v[64:65] offset:5376
    ds_write_b64 v1, v[66:67] offset:5408
    ds_write_b64 v1, v[68:69] offset:5440
    ds_write_b64 v1, v[70:71] offset:5472
    ds_write_b64 v1, v[72:73] offset:5504
    v_min_f32 v24, 0, v128
    v_min_f32 v25, 0, v129
    v_min_f32 v26, 0, v130
    v_min_f32 v27, 0, v131
    v_min_f32 v28, 0, v132
    v_min_f32 v29, 0, v133
    v_min_f32 v30, 0, v134
    v_min_f32 v31, 0, v135
    v_min_f32 v32, 0, v136
    v_min_f32 v33, 0, v137
    v_min_f32 v34, 0, v138
    v_min_f32 v35, 0, v139
    v_min_f32 v36, 0, v140
    v_min_f32 v37, 0, v141
    v_min_f32 v38, 0, v142
    v_min_f32 v39, 0, v143
    v_min_f32 v40, 0, v144
    v_min_f32 v41, 0, v145
    v_min_f32 v42, 0, v146
    v_min_f32 v43, 0, v147
    v_pk_mul_f32 v[24:25], v[24:25], s[96:97]
    v_pk_mul_f32 v[26:27], v[26:27], s[96:97]
    v_pk_mul_f32 v[28:29], v[28:29], s[96:97]
    v_pk_mul_f32 v[30:31], v[30:31], s[96:97]
    v_pk_mul_f32 v[32:33], v[32:33], s[96:97]
    v_pk_mul_f32 v[34:35], v[34:35], s[96:97]
    v_pk_mul_f32 v[36:37], v[36:37], s[96:97]
    v_pk_mul_f32 v[38:39], v[38:39], s[96:97]
    v_pk_mul_f32 v[40:41], v[40:41], s[96:97]
    v_pk_mul_f32 v[42:43], v[42:43], s[96:97]
    v_exp_f32 v24, v24
    v_exp_f32 v25, v25
    v_exp_f32 v26, v26
    v_exp_f32 v27, v27
    v_exp_f32 v28, v28
    v_exp_f32 v29, v29
    v_exp_f32 v30, v30
    v_exp_f32 v31, v31
    v_exp_f32 v32, v32
    v_exp_f32 v33, v33
    v_exp_f32 v34, v34
    v_exp_f32 v35, v35
    v_exp_f32 v36, v36
    v_exp_f32 v37, v37
    v_exp_f32 v38, v38
    v_exp_f32 v39, v39
    v_exp_f32 v40, v40
    v_exp_f32 v41, v41
    v_exp_f32 v42, v42
    v_exp_f32 v43, v43
    v_max_f32 v44, 0, v128
    v_max_f32 v45, 0, v129
    v_max_f32 v46, 0, v130
    v_max_f32 v47, 0, v131
    v_max_f32 v48, 0, v132
    v_max_f32 v49, 0, v133
    v_max_f32 v50, 0, v134
    v_max_f32 v51, 0, v135
    v_max_f32 v52, 0, v136
    v_max_f32 v53, 0, v137
    v_max_f32 v54, 0, v138
    v_max_f32 v55, 0, v139
    v_max_f32 v56, 0, v140
    v_max_f32 v57, 0, v141
    v_max_f32 v58, 0, v142
    v_max_f32 v59, 0, v143
    v_max_f32 v60, 0, v144
    v_max_f32 v61, 0, v145
    v_max_f32 v62, 0, v146
    v_max_f32 v63, 0, v147
    v_pk_add_f32 v[44:45], v[44:45], s[98:99]
    v_pk_add_f32 v[46:47], v[46:47], s[98:99]
    v_pk_add_f32 v[48:49], v[48:49], s[98:99]
    v_pk_add_f32 v[50:51], v[50:51], s[98:99]
    v_pk_add_f32 v[52:53], v[52:53], s[98:99]
    v_pk_add_f32 v[54:55], v[54:55], s[98:99]
    v_pk_add_f32 v[56:57], v[56:57], s[98:99]
    v_pk_add_f32 v[58:59], v[58:59], s[98:99]
    v_pk_add_f32 v[60:61], v[60:61], s[98:99]
    v_pk_add_f32 v[62:63], v[62:63], s[98:99]
    v_pk_add_f32 v[24:25], v[24:25], v[44:45]
    v_pk_add_f32 v[26:27], v[26:27], v[46:47]
    v_pk_add_f32 v[28:29], v[28:29], v[48:49]
    v_pk_add_f32 v[30:31], v[30:31], v[50:51]
    v_pk_add_f32 v[32:33], v[32:33], v[52:53]
    v_pk_add_f32 v[34:35], v[34:35], v[54:55]
    v_pk_add_f32 v[36:37], v[36:37], v[56:57]
    v_pk_add_f32 v[38:39], v[38:39], v[58:59]
    v_pk_add_f32 v[40:41], v[40:41], v[60:61]
    v_pk_add_f32 v[42:43], v[42:43], v[62:63]
    v_cvt_pk_bf16_f32 v64, v24, v25
    v_cvt_pk_bf16_f32 v65, v26, v27
    v_cvt_pk_bf16_f32 v66, v28, v29
    v_cvt_pk_bf16_f32 v67, v30, v31
    v_cvt_pk_bf16_f32 v68, v32, v33
    v_cvt_pk_bf16_f32 v69, v34, v35
    v_cvt_pk_bf16_f32 v70, v36, v37
    v_cvt_pk_bf16_f32 v71, v38, v39
    v_cvt_pk_bf16_f32 v72, v40, v41
    v_cvt_pk_bf16_f32 v73, v42, v43
    ds_write_b64 v1, v[64:65] offset:10752
    ds_write_b64 v1, v[66:67] offset:10784
    ds_write_b64 v1, v[68:69] offset:10816
    ds_write_b64 v1, v[70:71] offset:10848
    ds_write_b64 v1, v[72:73] offset:10880
    s_waitcnt lgkmcnt(0)
    s_barrier
    s_mul_i32 s49, s4, 245760
    s_add_u32 s49, s49, s46
    s_add_u32 s47, s7, 0
    s_lshl_b32 s47, s47, 6
    v_add_u32 v5, s47, v2
    v_mul_u32_u24 v6, 3277, v5
    v_lshrrev_b32 v6, 16, v6
    v_mul_u32_u24 v7, 20, v6
    v_sub_u32 v7, v5, v7
    v_lshlrev_b32 v7, 4, v7
    v_mul_u32_u24 v8, 336, v6
    v_add_u32 v8, v8, v7
    ds_read_b128 v[24:27], v8
    v_mul_u32_u24 v6, 1280, v6
    v_add_u32 v72, v6, v7
    s_add_u32 s47, s7, 8
    s_lshl_b32 s47, s47, 6
    v_add_u32 v5, s47, v2
    v_mul_u32_u24 v6, 3277, v5
    v_lshrrev_b32 v6, 16, v6
    v_mul_u32_u24 v7, 20, v6
    v_sub_u32 v7, v5, v7
    v_lshlrev_b32 v7, 4, v7
    v_mul_u32_u24 v8, 336, v6
    v_add_u32 v8, v8, v7
    ds_read_b128 v[28:31], v8
    v_mul_u32_u24 v6, 1280, v6
    v_add_u32 v73, v6, v7
    s_add_u32 s47, s7, 16
    s_lshl_b32 s47, s47, 6
    v_add_u32 v5, s47, v2
    v_mul_u32_u24 v6, 3277, v5
    v_lshrrev_b32 v6, 16, v6
    v_mul_u32_u24 v7, 20, v6
    v_sub_u32 v7, v5, v7
    v_lshlrev_b32 v7, 4, v7
    v_mul_u32_u24 v8, 336, v6
    v_add_u32 v8, v8, v7
    ds_read_b128 v[32:35], v8
    v_mul_u32_u24 v6, 1280, v6
    v_add_u32 v74, v6, v7
    s_add_u32 s47, s7, 24
    s_lshl_b32 s47, s47, 6
    v_add_u32 v5, s47, v2
    v_mul_u32_u24 v6, 3277, v5
    v_lshrrev_b32 v6, 16, v6
    v_mul_u32_u24 v7, 20, v6
    v_sub_u32 v7, v5, v7
    v_lshlrev_b32 v7, 4, v7
    v_mul_u32_u24 v8, 336, v6
    v_add_u32 v8, v8, v7
    ds_read_b128 v[36:39], v8
    v_mul_u32_u24 v6, 1280, v6
    v_add_u32 v75, v6, v7
    s_add_u32 s47, s7, 32
    s_lshl_b32 s47, s47, 6
    v_add_u32 v5, s47, v2
    v_mul_u32_u24 v6, 3277, v5
    v_lshrrev_b32 v6, 16, v6
    v_mul_u32_u24 v7, 20, v6
    v_sub_u32 v7, v5, v7
    v_lshlrev_b32 v7, 4, v7
    v_mul_u32_u24 v8, 336, v6
    v_add_u32 v8, v8, v7
    ds_read_b128 v[40:43], v8
    v_mul_u32_u24 v6, 1280, v6
    v_add_u32 v76, v6, v7
    s_add_u32 s47, s7, 40
    s_lshl_b32 s47, s47, 6
    v_add_u32 v5, s47, v2
    v_mul_u32_u24 v6, 3277, v5
    v_lshrrev_b32 v6, 16, v6
    v_mul_u32_u24 v7, 20, v6
    v_sub_u32 v7, v5, v7
    v_lshlrev_b32 v7, 4, v7
    v_mul_u32_u24 v8, 336, v6
    v_add_u32 v8, v8, v7
    ds_read_b128 v[44:47], v8
    v_mul_u32_u24 v6, 1280, v6
    v_add_u32 v77, v6, v7
    s_add_u32 s47, s7, 48
    s_lshl_b32 s47, s47, 6
    v_add_u32 v5, s47, v2
    v_mul_u32_u24 v6, 3277, v5
    v_lshrrev_b32 v6, 16, v6
    v_mul_u32_u24 v7, 20, v6
    v_sub_u32 v7, v5, v7
    v_lshlrev_b32 v7, 4, v7
    v_mul_u32_u24 v8, 336, v6
    v_add_u32 v8, v8, v7
    ds_read_b128 v[48:51], v8
    v_mul_u32_u24 v6, 1280, v6
    v_add_u32 v78, v6, v7
    s_cmp_ge_u32 s7, 4
    s_cbranch_scc1 K1_QST
    s_add_u32 s47, s7, 56
    s_lshl_b32 s47, s47, 6
    v_add_u32 v5, s47, v2
    v_mul_u32_u24 v6, 3277, v5
    v_lshrrev_b32 v6, 16, v6
    v_mul_u32_u24 v7, 20, v6
    v_sub_u32 v7, v5, v7
    v_lshlrev_b32 v7, 4, v7
    v_mul_u32_u24 v8, 336, v6
    v_add_u32 v8, v8, v7
    ds_read_b128 v[52:55], v8
    v_mul_u32_u24 v6, 1280, v6
    v_add_u32 v79, v6, v7
K1_QST:
    s_waitcnt lgkmcnt(0)
    buffer_store_dwordx4 v[24:27], v72, s[16:19], s49 offen
    buffer_store_dwordx4 v[28:31], v73, s[16:19], s49 offen
    buffer_store_dwordx4 v[32:35], v74, s[16:19], s49 offen
    buffer_store_dwordx4 v[36:39], v75, s[16:19], s49 offen
    buffer_store_dwordx4 v[40:43], v76, s[16:19], s49 offen
    buffer_store_dwordx4 v[44:47], v77, s[16:19], s49 offen
    buffer_store_dwordx4 v[48:51], v78, s[16:19], s49 offen
    s_cmp_ge_u32 s7, 4
    s_cbranch_scc1 K1_END
    buffer_store_dwordx4 v[52:55], v79, s[16:19], s49 offen
    s_branch K1_END
K1_EPI_H:
    s_mov_b32 s51, 3222493025
    s_mov_b32 s52, 3184710632
    v_mov_b32 v8, s51
    v_lshlrev_b32 v60, 16, v148
    v_and_b32 v61, 0xffff0000, v148
    v_lshlrev_b32 v62, 16, v149
    v_and_b32 v63, 0xffff0000, v149
    v_lshlrev_b32 v64, 16, v150
    v_and_b32 v65, 0xffff0000, v150
    v_lshlrev_b32 v66, 16, v151
    v_and_b32 v67, 0xffff0000, v151
    v_lshlrev_b32 v68, 16, v152
    v_and_b32 v69, 0xffff0000, v152
    v_lshlrev_b32 v70, 16, v153
    v_and_b32 v71, 0xffff0000, v153
    v_lshlrev_b32 v72, 16, v154
    v_and_b32 v73, 0xffff0000, v154
    v_lshlrev_b32 v74, 16, v155
    v_and_b32 v75, 0xffff0000, v155
    v_lshlrev_b32 v76, 16, v156
    v_and_b32 v77, 0xffff0000, v156
    v_lshlrev_b32 v78, 16, v157
    v_and_b32 v79, 0xffff0000, v157
    v_lshrrev_b32 v5, 2, v4
    v_sub_u32 v5, 0, v5
    v_and_b32 v5, 3, v5
    v_lshrrev_b32 v6, 1, v3
    v_xor_b32 v5, v5, v6
    v_lshlrev_b32 v5, 4, v5
    v_lshlrev_b32 v6, 6, v4
    v_add_u32 v5, v5, v6
    v_and_b32 v6, 1, v3
    v_lshlrev_b32 v6, 3, v6
    v_add_u32 v5, v5, v6
    s_lshl_b32 s49, s55, 5
    v_xor_b32 v6, s49, v5
    v_xor_b32 v7, 32, v6
    s_mul_i32 s49, s55, 80
    s_add_u32 s49, s49, 0
    s_lshr_b32 s49, s49, 5
    s_lshl_b32 s96, s49, 12
    s_mul_i32 s49, s55, 80
    s_add_u32 s49, s49, 16
    s_lshr_b32 s49, s49, 5
    s_lshl_b32 s97, s49, 12
    s_mul_i32 s49, s55, 80
    s_add_u32 s49, s49, 32
    s_lshr_b32 s49, s49, 5
    s_lshl_b32 s98, s49, 12
    s_mul_i32 s49, s55, 80
    s_add_u32 s49, s49, 48
    s_lshr_b32 s49, s49, 5
    s_lshl_b32 s99, s49, 12
    s_mul_i32 s49, s55, 80
    s_add_u32 s49, s49, 64
    s_lshr_b32 s49, s49, 5
    s_lshl_b32 s100, s49, 12
    s_mul_i32 s53, s54, 48
    s_mov_b32 s90, 3222493025
    s_mov_b32 s91, 3222493025
    s_mov_b32 s92, 3184710632
    s_mov_b32 s93, 3184710632
    s_mov_b32 s94, 1106247680
    v_mov_b32 v80, s90
    v_mov_b32 v81, s90
    v_mov_b32 v82, 1.0
    v_mov_b32 v83, 1.0
    s_lshr_b32 s47, s53, 6
    s_mul_i32 s47, s47, 20480
    s_and_b32 s48, s53, 63
    s_lshl_b32 s48, s48, 6
    s_add_u32 s47, s47, s48
    v_add_u32 v9, s47, v6
    v_add_u32 v10, s47, v7
    v_pk_add_f32 v[88:89], v[88:89], v[60:61]
    v_pk_add_f32 v[90:91], v[90:91], v[62:63]
    v_pk_add_f32 v[92:93], v[92:93], v[64:65]
    v_pk_add_f32 v[94:95], v[94:95], v[66:67]
    v_pk_add_f32 v[96:97], v[96:97], v[68:69]
    v_pk_add_f32 v[98:99], v[98:99], v[70:71]
    v_pk_add_f32 v[100:101], v[100:101], v[72:73]
    v_pk_add_f32 v[102:103], v[102:103], v[74:75]
    v_pk_add_f32 v[104:105], v[104:105], v[76:77]
    v_pk_add_f32 v[106:107], v[106:107], v[78:79]
    v_pk_mul_f32 v[24:25], v[88:89], v[88:89]
    v_pk_mul_f32 v[26:27], v[90:91], v[90:91]
    v_pk_mul_f32 v[28:29], v[92:93], v[92:93]
    v_pk_mul_f32 v[30:31], v[94:95], v[94:95]
    v_pk_mul_f32 v[32:33], v[96:97], v[96:97]
    v_pk_mul_f32 v[34:35], v[98:99], v[98:99]
    v_pk_mul_f32 v[36:37], v[100:101], v[100:101]
    v_pk_mul_f32 v[38:39], v[102:103], v[102:103]
    v_pk_mul_f32 v[40:41], v[104:105], v[104:105]
    v_pk_mul_f32 v[42:43], v[106:107], v[106:107]
    v_pk_fma_f32 v[24:25], v[24:25], s[92:93], v[80:81]
    v_pk_fma_f32 v[26:27], v[26:27], s[92:93], v[80:81]
    v_pk_fma_f32 v[28:29], v[28:29], s[92:93], v[80:81]
    v_pk_fma_f32 v[30:31], v[30:31], s[92:93], v[80:81]
    v_pk_fma_f32 v[32:33], v[32:33], s[92:93], v[80:81]
    v_pk_fma_f32 v[34:35], v[34:35], s[92:93], v[80:81]
    v_pk_fma_f32 v[36:37], v[36:37], s[92:93], v[80:81]
    v_pk_fma_f32 v[38:39], v[38:39], s[92:93], v[80:81]
    v_pk_fma_f32 v[40:41], v[40:41], s[92:93], v[80:81]
    v_pk_fma_f32 v[42:43], v[42:43], s[92:93], v[80:81]
    v_pk_mul_f32 v[24:25], v[24:25], v[88:89]
    v_pk_mul_f32 v[26:27], v[26:27], v[90:91]
    v_pk_mul_f32 v[28:29], v[28:29], v[92:93]
    v_pk_mul_f32 v[30:31], v[30:31], v[94:95]
    v_pk_mul_f32 v[32:33], v[32:33], v[96:97]
    v_pk_mul_f32 v[34:35], v[34:35], v[98:99]
    v_pk_mul_f32 v[36:37], v[36:37], v[100:101]
    v_pk_mul_f32 v[38:39], v[38:39], v[102:103]
    v_pk_mul_f32 v[40:41], v[40:41], v[104:105]
    v_pk_mul_f32 v[42:43], v[42:43], v[106:107]
    v_min_f32 v24, s94, v24
    v_min_f32 v25, s94, v25
    v_min_f32 v26, s94, v26
    v_min_f32 v27, s94, v27
    v_min_f32 v28, s94, v28
    v_min_f32 v29, s94, v29
    v_min_f32 v30, s94, v30
    v_min_f32 v31, s94, v31
    v_min_f32 v32, s94, v32
    v_min_f32 v33, s94, v33
    v_min_f32 v34, s94, v34
    v_min_f32 v35, s94, v35
    v_min_f32 v36, s94, v36
    v_min_f32 v37, s94, v37
    v_min_f32 v38, s94, v38
    v_min_f32 v39, s94, v39
    v_min_f32 v40, s94, v40
    v_min_f32 v41, s94, v41
    v_min_f32 v42, s94, v42
    v_min_f32 v43, s94, v43
    v_exp_f32 v24, v24
    v_exp_f32 v25, v25
    v_exp_f32 v26, v26
    v_exp_f32 v27, v27
    v_exp_f32 v28, v28
    v_exp_f32 v29, v29
    v_exp_f32 v30, v30
    v_exp_f32 v31, v31
    v_exp_f32 v32, v32
    v_exp_f32 v33, v33
    v_exp_f32 v34, v34
    v_exp_f32 v35, v35
    v_exp_f32 v36, v36
    v_exp_f32 v37, v37
    v_exp_f32 v38, v38
    v_exp_f32 v39, v39
    v_exp_f32 v40, v40
    v_exp_f32 v41, v41
    v_exp_f32 v42, v42
    v_exp_f32 v43, v43
    v_add_u32 v11, s96, v9
    v_add_u32 v12, s97, v10
    v_add_u32 v13, s98, v9
    v_add_u32 v14, s99, v10
    v_add_u32 v15, s100, v9
    v_pk_add_f32 v[24:25], v[24:25], v[82:83]
    v_pk_add_f32 v[26:27], v[26:27], v[82:83]
    v_pk_add_f32 v[28:29], v[28:29], v[82:83]
    v_pk_add_f32 v[30:31], v[30:31], v[82:83]
    v_pk_add_f32 v[32:33], v[32:33], v[82:83]
    v_pk_add_f32 v[34:35], v[34:35], v[82:83]
    v_pk_add_f32 v[36:37], v[36:37], v[82:83]
    v_pk_add_f32 v[38:39], v[38:39], v[82:83]
    v_pk_add_f32 v[40:41], v[40:41], v[82:83]
    v_pk_add_f32 v[42:43], v[42:43], v[82:83]
    v_mul_f32 v44, v24, v25
    v_mul_f32 v45, v26, v27
    v_mul_f32 v46, v28, v29
    v_mul_f32 v47, v30, v31
    v_mul_f32 v48, v32, v33
    v_mul_f32 v49, v34, v35
    v_mul_f32 v50, v36, v37
    v_mul_f32 v51, v38, v39
    v_mul_f32 v52, v40, v41
    v_mul_f32 v53, v42, v43
    v_mul_f32 v54, v44, v45
    v_mul_f32 v55, v46, v47
    v_mul_f32 v56, v48, v49
    v_mul_f32 v57, v50, v51
    v_mul_f32 v58, v52, v53
    v_rcp_f32 v54, v54
    v_rcp_f32 v55, v55
    v_rcp_f32 v56, v56
    v_rcp_f32 v57, v57
    v_rcp_f32 v58, v58
    s_nop 0
    v_mul_f32 v84, v54, v45
    v_mul_f32 v85, v54, v44
    v_mul_f32 v44, v84, v25
    v_mul_f32 v45, v84, v24
    v_mul_f32 v24, v44, v88
    v_mul_f32 v25, v45, v89
    v_mul_f32 v44, v85, v27
    v_mul_f32 v45, v85, v26
    v_mul_f32 v26, v44, v90
    v_mul_f32 v27, v45, v91
    v_mul_f32 v86, v55, v47
    v_mul_f32 v87, v55, v46
    v_mul_f32 v46, v86, v29
    v_mul_f32 v47, v86, v28
    v_mul_f32 v28, v46, v92
    v_mul_f32 v29, v47, v93
    v_mul_f32 v46, v87, v31
    v_mul_f32 v47, v87, v30
    v_mul_f32 v30, v46, v94
    v_mul_f32 v31, v47, v95
    v_mul_f32 v84, v56, v49
    v_mul_f32 v85, v56, v48
    v_mul_f32 v48, v84, v33
    v_mul_f32 v49, v84, v32
    v_mul_f32 v32, v48, v96
    v_mul_f32 v33, v49, v97
    v_mul_f32 v48, v85, v35
    v_mul_f32 v49, v85, v34
    v_mul_f32 v34, v48, v98
    v_mul_f32 v35, v49, v99
    v_mul_f32 v86, v57, v51
    v_mul_f32 v87, v57, v50
    v_mul_f32 v50, v86, v37
    v_mul_f32 v51, v86, v36
    v_mul_f32 v36, v50, v100
    v_mul_f32 v37, v51, v101
    v_mul_f32 v50, v87, v39
    v_mul_f32 v51, v87, v38
    v_mul_f32 v38, v50, v102
    v_mul_f32 v39, v51, v103
    v_mul_f32 v84, v58, v53
    v_mul_f32 v85, v58, v52
    v_mul_f32 v52, v84, v41
    v_mul_f32 v53, v84, v40
    v_mul_f32 v40, v52, v104
    v_mul_f32 v41, v53, v105
    v_mul_f32 v52, v85, v43
    v_mul_f32 v53, v85, v42
    v_mul_f32 v42, v52, v106
    v_mul_f32 v43, v53, v107
    v_cvt_pk_bf16_f32 v44, v24, v25
    v_cvt_pk_bf16_f32 v45, v26, v27
    v_cvt_pk_bf16_f32 v46, v28, v29
    v_cvt_pk_bf16_f32 v47, v30, v31
    v_cvt_pk_bf16_f32 v48, v32, v33
    v_cvt_pk_bf16_f32 v49, v34, v35
    v_cvt_pk_bf16_f32 v50, v36, v37
    v_cvt_pk_bf16_f32 v51, v38, v39
    v_cvt_pk_bf16_f32 v52, v40, v41
    v_cvt_pk_bf16_f32 v53, v42, v43
    ds_write_b64 v11, v[44:45]
    ds_write_b64 v12, v[46:47]
    ds_write_b64 v13, v[48:49]
    ds_write_b64 v14, v[50:51]
    ds_write_b64 v15, v[52:53]
    s_add_u32 s53, s53, 16
    s_lshr_b32 s47, s53, 6
    s_mul_i32 s47, s47, 20480
    s_and_b32 s48, s53, 63
    s_lshl_b32 s48, s48, 6
    s_add_u32 s47, s47, s48
    v_add_u32 v9, s47, v6
    v_add_u32 v10, s47, v7
    v_pk_add_f32 v[108:109], v[108:109], v[60:61]
    v_pk_add_f32 v[110:111], v[110:111], v[62:63]
    v_pk_add_f32 v[112:113], v[112:113], v[64:65]
    v_pk_add_f32 v[114:115], v[114:115], v[66:67]
    v_pk_add_f32 v[116:117], v[116:117], v[68:69]
    v_pk_add_f32 v[118:119], v[118:119], v[70:71]
    v_pk_add_f32 v[120:121], v[120:121], v[72:73]
    v_pk_add_f32 v[122:123], v[122:123], v[74:75]
    v_pk_add_f32 v[124:125], v[124:125], v[76:77]
    v_pk_add_f32 v[126:127], v[126:127], v[78:79]
    v_pk_mul_f32 v[24:25], v[108:109], v[108:109]
    v_pk_mul_f32 v[26:27], v[110:111], v[110:111]
    v_pk_mul_f32 v[28:29], v[112:113], v[112:113]
    v_pk_mul_f32 v[30:31], v[114:115], v[114:115]
    v_pk_mul_f32 v[32:33], v[116:117], v[116:117]
    v_pk_mul_f32 v[34:35], v[118:119], v[118:119]
    v_pk_mul_f32 v[36:37], v[120:121], v[120:121]
    v_pk_mul_f32 v[38:39], v[122:123], v[122:123]
    v_pk_mul_f32 v[40:41], v[124:125], v[124:125]
    v_pk_mul_f32 v[42:43], v[126:127], v[126:127]
    v_pk_fma_f32 v[24:25], v[24:25], s[92:93], v[80:81]
    v_pk_fma_f32 v[26:27], v[26:27], s[92:93], v[80:81]
    v_pk_fma_f32 v[28:29], v[28:29], s[92:93], v[80:81]
    v_pk_fma_f32 v[30:31], v[30:31], s[92:93], v[80:81]
    v_pk_fma_f32 v[32:33], v[32:33], s[92:93], v[80:81]
    v_pk_fma_f32 v[34:35], v[34:35], s[92:93], v[80:81]
    v_pk_fma_f32 v[36:37], v[36:37], s[92:93], v[80:81]
    v_pk_fma_f32 v[38:39], v[38:39], s[92:93], v[80:81]
    v_pk_fma_f32 v[40:41], v[40:41], s[92:93], v[80:81]
    v_pk_fma_f32 v[42:43], v[42:43], s[92:93], v[80:81]
    v_pk_mul_f32 v[24:25], v[24:25], v[108:109]
    v_pk_mul_f32 v[26:27], v[26:27], v[110:111]
    v_pk_mul_f32 v[28:29], v[28:29], v[112:113]
    v_pk_mul_f32 v[30:31], v[30:31], v[114:115]
    v_pk_mul_f32 v[32:33], v[32:33], v[116:117]
    v_pk_mul_f32 v[34:35], v[34:35], v[118:119]
    v_pk_mul_f32 v[36:37], v[36:37], v[120:121]
    v_pk_mul_f32 v[38:39], v[38:39], v[122:123]
    v_pk_mul_f32 v[40:41], v[40:41], v[124:125]
    v_pk_mul_f32 v[42:43], v[42:43], v[126:127]
    v_min_f32 v24, s94, v24
    v_min_f32 v25, s94, v25
    v_min_f32 v26, s94, v26
    v_min_f32 v27, s94, v27
    v_min_f32 v28, s94, v28
    v_min_f32 v29, s94, v29
    v_min_f32 v30, s94, v30
    v_min_f32 v31, s94, v31
    v_min_f32 v32, s94, v32
    v_min_f32 v33, s94, v33
    v_min_f32 v34, s94, v34
    v_min_f32 v35, s94, v35
    v_min_f32 v36, s94, v36
    v_min_f32 v37, s94, v37
    v_min_f32 v38, s94, v38
    v_min_f32 v39, s94, v39
    v_min_f32 v40, s94, v40
    v_min_f32 v41, s94, v41
    v_min_f32 v42, s94, v42
    v_min_f32 v43, s94, v43
    v_exp_f32 v24, v24
    v_exp_f32 v25, v25
    v_exp_f32 v26, v26
    v_exp_f32 v27, v27
    v_exp_f32 v28, v28
    v_exp_f32 v29, v29
    v_exp_f32 v30, v30
    v_exp_f32 v31, v31
    v_exp_f32 v32, v32
    v_exp_f32 v33, v33
    v_exp_f32 v34, v34
    v_exp_f32 v35, v35
    v_exp_f32 v36, v36
    v_exp_f32 v37, v37
    v_exp_f32 v38, v38
    v_exp_f32 v39, v39
    v_exp_f32 v40, v40
    v_exp_f32 v41, v41
    v_exp_f32 v42, v42
    v_exp_f32 v43, v43
    v_add_u32 v11, s96, v9
    v_add_u32 v12, s97, v10
    v_add_u32 v13, s98, v9
    v_add_u32 v14, s99, v10
    v_add_u32 v15, s100, v9
    v_pk_add_f32 v[24:25], v[24:25], v[82:83]
    v_pk_add_f32 v[26:27], v[26:27], v[82:83]
    v_pk_add_f32 v[28:29], v[28:29], v[82:83]
    v_pk_add_f32 v[30:31], v[30:31], v[82:83]
    v_pk_add_f32 v[32:33], v[32:33], v[82:83]
    v_pk_add_f32 v[34:35], v[34:35], v[82:83]
    v_pk_add_f32 v[36:37], v[36:37], v[82:83]
    v_pk_add_f32 v[38:39], v[38:39], v[82:83]
    v_pk_add_f32 v[40:41], v[40:41], v[82:83]
    v_pk_add_f32 v[42:43], v[42:43], v[82:83]
    v_mul_f32 v44, v24, v25
    v_mul_f32 v45, v26, v27
    v_mul_f32 v46, v28, v29
    v_mul_f32 v47, v30, v31
    v_mul_f32 v48, v32, v33
    v_mul_f32 v49, v34, v35
    v_mul_f32 v50, v36, v37
    v_mul_f32 v51, v38, v39
    v_mul_f32 v52, v40, v41
    v_mul_f32 v53, v42, v43
    v_mul_f32 v54, v44, v45
    v_mul_f32 v55, v46, v47
    v_mul_f32 v56, v48, v49
    v_mul_f32 v57, v50, v51
    v_mul_f32 v58, v52, v53
    v_rcp_f32 v54, v54
    v_rcp_f32 v55, v55
    v_rcp_f32 v56, v56
    v_rcp_f32 v57, v57
    v_rcp_f32 v58, v58
    s_nop 0
    v_mul_f32 v84, v54, v45
    v_mul_f32 v85, v54, v44
    v_mul_f32 v44, v84, v25
    v_mul_f32 v45, v84, v24
    v_mul_f32 v24, v44, v108
    v_mul_f32 v25, v45, v109
    v_mul_f32 v44, v85, v27
    v_mul_f32 v45, v85, v26
    v_mul_f32 v26, v44, v110
    v_mul_f32 v27, v45, v111
    v_mul_f32 v86, v55, v47
    v_mul_f32 v87, v55, v46
    v_mul_f32 v46, v86, v29
    v_mul_f32 v47, v86, v28
    v_mul_f32 v28, v46, v112
    v_mul_f32 v29, v47, v113
    v_mul_f32 v46, v87, v31
    v_mul_f32 v47, v87, v30
    v_mul_f32 v30, v46, v114
    v_mul_f32 v31, v47, v115
    v_mul_f32 v84, v56, v49
    v_mul_f32 v85, v56, v48
    v_mul_f32 v48, v84, v33
    v_mul_f32 v49, v84, v32
    v_mul_f32 v32, v48, v116
    v_mul_f32 v33, v49, v117
    v_mul_f32 v48, v85, v35
    v_mul_f32 v49, v85, v34
    v_mul_f32 v34, v48, v118
    v_mul_f32 v35, v49, v119
    v_mul_f32 v86, v57, v51
    v_mul_f32 v87, v57, v50
    v_mul_f32 v50, v86, v37
    v_mul_f32 v51, v86, v36
    v_mul_f32 v36, v50, v120
    v_mul_f32 v37, v51, v121
    v_mul_f32 v50, v87, v39
    v_mul_f32 v51, v87, v38
    v_mul_f32 v38, v50, v122
    v_mul_f32 v39, v51, v123
    v_mul_f32 v84, v58, v53
    v_mul_f32 v85, v58, v52
    v_mul_f32 v52, v84, v41
    v_mul_f32 v53, v84, v40
    v_mul_f32 v40, v52, v124
    v_mul_f32 v41, v53, v125
    v_mul_f32 v52, v85, v43
    v_mul_f32 v53, v85, v42
    v_mul_f32 v42, v52, v126
    v_mul_f32 v43, v53, v127
    v_cvt_pk_bf16_f32 v44, v24, v25
    v_cvt_pk_bf16_f32 v45, v26, v27
    v_cvt_pk_bf16_f32 v46, v28, v29
    v_cvt_pk_bf16_f32 v47, v30, v31
    v_cvt_pk_bf16_f32 v48, v32, v33
    v_cvt_pk_bf16_f32 v49, v34, v35
    v_cvt_pk_bf16_f32 v50, v36, v37
    v_cvt_pk_bf16_f32 v51, v38, v39
    v_cvt_pk_bf16_f32 v52, v40, v41
    v_cvt_pk_bf16_f32 v53, v42, v43
    ds_write_b64 v11, v[44:45]
    ds_write_b64 v12, v[46:47]
    ds_write_b64 v13, v[48:49]
    ds_write_b64 v14, v[50:51]
    ds_write_b64 v15, v[52:53]
    s_add_u32 s53, s53, 16
    s_lshr_b32 s47, s53, 6
    s_mul_i32 s47, s47, 20480
    s_and_b32 s48, s53, 63
    s_lshl_b32 s48, s48, 6
    s_add_u32 s47, s47, s48
    v_add_u32 v9, s47, v6
    v_add_u32 v10, s47, v7
    v_pk_add_f32 v[128:129], v[128:129], v[60:61]
    v_pk_add_f32 v[130:131], v[130:131], v[62:63]
    v_pk_add_f32 v[132:133], v[132:133], v[64:65]
    v_pk_add_f32 v[134:135], v[134:135], v[66:67]
    v_pk_add_f32 v[136:137], v[136:137], v[68:69]
    v_pk_add_f32 v[138:139], v[138:139], v[70:71]
    v_pk_add_f32 v[140:141], v[140:141], v[72:73]
    v_pk_add_f32 v[142:143], v[142:143], v[74:75]
    v_pk_add_f32 v[144:145], v[144:145], v[76:77]
    v_pk_add_f32 v[146:147], v[146:147], v[78:79]
    v_pk_mul_f32 v[24:25], v[128:129], v[128:129]
    v_pk_mul_f32 v[26:27], v[130:131], v[130:131]
    v_pk_mul_f32 v[28:29], v[132:133], v[132:133]
    v_pk_mul_f32 v[30:31], v[134:135], v[134:135]
    v_pk_mul_f32 v[32:33], v[136:137], v[136:137]
    v_pk_mul_f32 v[34:35], v[138:139], v[138:139]
    v_pk_mul_f32 v[36:37], v[140:141], v[140:141]
    v_pk_mul_f32 v[38:39], v[142:143], v[142:143]
    v_pk_mul_f32 v[40:41], v[144:145], v[144:145]
    v_pk_mul_f32 v[42:43], v[146:147], v[146:147]
    v_pk_fma_f32 v[24:25], v[24:25], s[92:93], v[80:81]
    v_pk_fma_f32 v[26:27], v[26:27], s[92:93], v[80:81]
    v_pk_fma_f32 v[28:29], v[28:29], s[92:93], v[80:81]
    v_pk_fma_f32 v[30:31], v[30:31], s[92:93], v[80:81]
    v_pk_fma_f32 v[32:33], v[32:33], s[92:93], v[80:81]
    v_pk_fma_f32 v[34:35], v[34:35], s[92:93], v[80:81]
    v_pk_fma_f32 v[36:37], v[36:37], s[92:93], v[80:81]
    v_pk_fma_f32 v[38:39], v[38:39], s[92:93], v[80:81]
    v_pk_fma_f32 v[40:41], v[40:41], s[92:93], v[80:81]
    v_pk_fma_f32 v[42:43], v[42:43], s[92:93], v[80:81]
    v_pk_mul_f32 v[24:25], v[24:25], v[128:129]
    v_pk_mul_f32 v[26:27], v[26:27], v[130:131]
    v_pk_mul_f32 v[28:29], v[28:29], v[132:133]
    v_pk_mul_f32 v[30:31], v[30:31], v[134:135]
    v_pk_mul_f32 v[32:33], v[32:33], v[136:137]
    v_pk_mul_f32 v[34:35], v[34:35], v[138:139]
    v_pk_mul_f32 v[36:37], v[36:37], v[140:141]
    v_pk_mul_f32 v[38:39], v[38:39], v[142:143]
    v_pk_mul_f32 v[40:41], v[40:41], v[144:145]
    v_pk_mul_f32 v[42:43], v[42:43], v[146:147]
    v_min_f32 v24, s94, v24
    v_min_f32 v25, s94, v25
    v_min_f32 v26, s94, v26
    v_min_f32 v27, s94, v27
    v_min_f32 v28, s94, v28
    v_min_f32 v29, s94, v29
    v_min_f32 v30, s94, v30
    v_min_f32 v31, s94, v31
    v_min_f32 v32, s94, v32
    v_min_f32 v33, s94, v33
    v_min_f32 v34, s94, v34
    v_min_f32 v35, s94, v35
    v_min_f32 v36, s94, v36
    v_min_f32 v37, s94, v37
    v_min_f32 v38, s94, v38
    v_min_f32 v39, s94, v39
    v_min_f32 v40, s94, v40
    v_min_f32 v41, s94, v41
    v_min_f32 v42, s94, v42
    v_min_f32 v43, s94, v43
    v_exp_f32 v24, v24
    v_exp_f32 v25, v25
    v_exp_f32 v26, v26
    v_exp_f32 v27, v27
    v_exp_f32 v28, v28
    v_exp_f32 v29, v29
    v_exp_f32 v30, v30
    v_exp_f32 v31, v31
    v_exp_f32 v32, v32
    v_exp_f32 v33, v33
    v_exp_f32 v34, v34
    v_exp_f32 v35, v35
    v_exp_f32 v36, v36
    v_exp_f32 v37, v37
    v_exp_f32 v38, v38
    v_exp_f32 v39, v39
    v_exp_f32 v40, v40
    v_exp_f32 v41, v41
    v_exp_f32 v42, v42
    v_exp_f32 v43, v43
    v_add_u32 v11, s96, v9
    v_add_u32 v12, s97, v10
    v_add_u32 v13, s98, v9
    v_add_u32 v14, s99, v10
    v_add_u32 v15, s100, v9
    v_pk_add_f32 v[24:25], v[24:25], v[82:83]
    v_pk_add_f32 v[26:27], v[26:27], v[82:83]
    v_pk_add_f32 v[28:29], v[28:29], v[82:83]
    v_pk_add_f32 v[30:31], v[30:31], v[82:83]
    v_pk_add_f32 v[32:33], v[32:33], v[82:83]
    v_pk_add_f32 v[34:35], v[34:35], v[82:83]
    v_pk_add_f32 v[36:37], v[36:37], v[82:83]
    v_pk_add_f32 v[38:39], v[38:39], v[82:83]
    v_pk_add_f32 v[40:41], v[40:41], v[82:83]
    v_pk_add_f32 v[42:43], v[42:43], v[82:83]
    v_mul_f32 v44, v24, v25
    v_mul_f32 v45, v26, v27
    v_mul_f32 v46, v28, v29
    v_mul_f32 v47, v30, v31
    v_mul_f32 v48, v32, v33
    v_mul_f32 v49, v34, v35
    v_mul_f32 v50, v36, v37
    v_mul_f32 v51, v38, v39
    v_mul_f32 v52, v40, v41
    v_mul_f32 v53, v42, v43
    v_mul_f32 v54, v44, v45
    v_mul_f32 v55, v46, v47
    v_mul_f32 v56, v48, v49
    v_mul_f32 v57, v50, v51
    v_mul_f32 v58, v52, v53
    v_rcp_f32 v54, v54
    v_rcp_f32 v55, v55
    v_rcp_f32 v56, v56
    v_rcp_f32 v57, v57
    v_rcp_f32 v58, v58
    s_nop 0
    v_mul_f32 v84, v54, v45
    v_mul_f32 v85, v54, v44
    v_mul_f32 v44, v84, v25
    v_mul_f32 v45, v84, v24
    v_mul_f32 v24, v44, v128
    v_mul_f32 v25, v45, v129
    v_mul_f32 v44, v85, v27
    v_mul_f32 v45, v85, v26
    v_mul_f32 v26, v44, v130
    v_mul_f32 v27, v45, v131
    v_mul_f32 v86, v55, v47
    v_mul_f32 v87, v55, v46
    v_mul_f32 v46, v86, v29
    v_mul_f32 v47, v86, v28
    v_mul_f32 v28, v46, v132
    v_mul_f32 v29, v47, v133
    v_mul_f32 v46, v87, v31
    v_mul_f32 v47, v87, v30
    v_mul_f32 v30, v46, v134
    v_mul_f32 v31, v47, v135
    v_mul_f32 v84, v56, v49
    v_mul_f32 v85, v56, v48
    v_mul_f32 v48, v84, v33
    v_mul_f32 v49, v84, v32
    v_mul_f32 v32, v48, v136
    v_mul_f32 v33, v49, v137
    v_mul_f32 v48, v85, v35
    v_mul_f32 v49, v85, v34
    v_mul_f32 v34, v48, v138
    v_mul_f32 v35, v49, v139
    v_mul_f32 v86, v57, v51
    v_mul_f32 v87, v57, v50
    v_mul_f32 v50, v86, v37
    v_mul_f32 v51, v86, v36
    v_mul_f32 v36, v50, v140
    v_mul_f32 v37, v51, v141
    v_mul_f32 v50, v87, v39
    v_mul_f32 v51, v87, v38
    v_mul_f32 v38, v50, v142
    v_mul_f32 v39, v51, v143
    v_mul_f32 v84, v58, v53
    v_mul_f32 v85, v58, v52
    v_mul_f32 v52, v84, v41
    v_mul_f32 v53, v84, v40
    v_mul_f32 v40, v52, v144
    v_mul_f32 v41, v53, v145
    v_mul_f32 v52, v85, v43
    v_mul_f32 v53, v85, v42
    v_mul_f32 v42, v52, v146
    v_mul_f32 v43, v53, v147
    v_cvt_pk_bf16_f32 v44, v24, v25
    v_cvt_pk_bf16_f32 v45, v26, v27
    v_cvt_pk_bf16_f32 v46, v28, v29
    v_cvt_pk_bf16_f32 v47, v30, v31
    v_cvt_pk_bf16_f32 v48, v32, v33
    v_cvt_pk_bf16_f32 v49, v34, v35
    v_cvt_pk_bf16_f32 v50, v36, v37
    v_cvt_pk_bf16_f32 v51, v38, v39
    v_cvt_pk_bf16_f32 v52, v40, v41
    v_cvt_pk_bf16_f32 v53, v42, v43
    ds_write_b64 v11, v[44:45]
    ds_write_b64 v12, v[46:47]
    ds_write_b64 v13, v[48:49]
    ds_write_b64 v14, v[50:51]
    ds_write_b64 v15, v[52:53]
    s_add_u32 s53, s53, 16
    s_waitcnt lgkmcnt(0)
    s_barrier
    v_lshlrev_b32 v1, 4, v2
    s_sub_u32 s51, s5, 12
    s_mul_i32 s51, s51, 5
    s_mul_i32 s52, s4, 3
    s_add_u32 s47, s7, 0
    s_lshl_b32 s48, s47, 10
    v_add_u32 v5, s48, v1
    ds_read_b128 v[24:27], v5
    s_add_u32 s47, s7, 8
    s_lshl_b32 s48, s47, 10
    v_add_u32 v5, s48, v1
    ds_read_b128 v[28:31], v5
    s_add_u32 s47, s7, 16
    s_lshl_b32 s48, s47, 10
    v_add_u32 v5, s48, v1
    ds_read_b128 v[32:35], v5
    s_add_u32 s47, s7, 24
    s_lshl_b32 s48, s47, 10
    v_add_u32 v5, s48, v1
    ds_read_b128 v[36:39], v5
    s_add_u32 s47, s7, 32
    s_lshl_b32 s48, s47, 10
    v_add_u32 v5, s48, v1
    ds_read_b128 v[40:43], v5
    s_add_u32 s47, s7, 40
    s_lshl_b32 s48, s47, 10
    v_add_u32 v5, s48, v1
    ds_read_b128 v[44:47], v5
    s_add_u32 s47, s7, 48
    s_lshl_b32 s48, s47, 10
    v_add_u32 v5, s48, v1
    ds_read_b128 v[48:51], v5
    s_add_u32 s47, s7, 56
    s_lshl_b32 s48, s47, 10
    v_add_u32 v5, s48, v1
    ds_read_b128 v[52:55], v5
    s_waitcnt lgkmcnt(0)
    s_add_u32 s47, s7, 0
    s_cmp_ge_u32 s47, 60
    s_cbranch_scc1 K1_END
    s_lshr_b32 s48, s47, 2
    s_mul_i32 s49, s48, 13
    s_lshr_b32 s49, s49, 6
    s_mul_i32 s53, s49, 5
    s_sub_u32 s48, s48, s53
    s_add_u32 s48, s48, s51
    s_cmp_ge_u32 s48, 54
    s_cbranch_scc1 K1_HSK0
    s_add_u32 s49, s49, s52
    s_mul_i32 s49, s49, 54
    s_add_u32 s49, s49, s48
    s_lshl_b32 s49, s49, 12
    s_and_b32 s47, s47, 3
    s_lshl_b32 s47, s47, 10
    s_add_u32 s49, s49, s47
    buffer_store_dwordx4 v[24:27], v1, s[16:19], s49 offen
K1_HSK0:
    s_add_u32 s47, s7, 8
    s_cmp_ge_u32 s47, 60
    s_cbranch_scc1 K1_END
    s_lshr_b32 s48, s47, 2
    s_mul_i32 s49, s48, 13
    s_lshr_b32 s49, s49, 6
    s_mul_i32 s53, s49, 5
    s_sub_u32 s48, s48, s53
    s_add_u32 s48, s48, s51
    s_cmp_ge_u32 s48, 54
    s_cbranch_scc1 K1_HSK1
    s_add_u32 s49, s49, s52
    s_mul_i32 s49, s49, 54
    s_add_u32 s49, s49, s48
    s_lshl_b32 s49, s49, 12
    s_and_b32 s47, s47, 3
    s_lshl_b32 s47, s47, 10
    s_add_u32 s49, s49, s47
    buffer_store_dwordx4 v[28:31], v1, s[16:19], s49 offen
K1_HSK1:
    s_add_u32 s47, s7, 16
    s_cmp_ge_u32 s47, 60
    s_cbranch_scc1 K1_END
    s_lshr_b32 s48, s47, 2
    s_mul_i32 s49, s48, 13
    s_lshr_b32 s49, s49, 6
    s_mul_i32 s53, s49, 5
    s_sub_u32 s48, s48, s53
    s_add_u32 s48, s48, s51
    s_cmp_ge_u32 s48, 54
    s_cbranch_scc1 K1_HSK2
    s_add_u32 s49, s49, s52
    s_mul_i32 s49, s49, 54
    s_add_u32 s49, s49, s48
    s_lshl_b32 s49, s49, 12
    s_and_b32 s47, s47, 3
    s_lshl_b32 s47, s47, 10
    s_add_u32 s49, s49, s47
    buffer_store_dwordx4 v[32:35], v1, s[16:19], s49 offen
K1_HSK2:
    s_add_u32 s47, s7, 24
    s_cmp_ge_u32 s47, 60
    s_cbranch_scc1 K1_END
    s_lshr_b32 s48, s47, 2
    s_mul_i32 s49, s48, 13
    s_lshr_b32 s49, s49, 6
    s_mul_i32 s53, s49, 5
    s_sub_u32 s48, s48, s53
    s_add_u32 s48, s48, s51
    s_cmp_ge_u32 s48, 54
    s_cbranch_scc1 K1_HSK3
    s_add_u32 s49, s49, s52
    s_mul_i32 s49, s49, 54
    s_add_u32 s49, s49, s48
    s_lshl_b32 s49, s49, 12
    s_and_b32 s47, s47, 3
    s_lshl_b32 s47, s47, 10
    s_add_u32 s49, s49, s47
    buffer_store_dwordx4 v[36:39], v1, s[16:19], s49 offen
K1_HSK3:
    s_add_u32 s47, s7, 32
    s_cmp_ge_u32 s47, 60
    s_cbranch_scc1 K1_END
    s_lshr_b32 s48, s47, 2
    s_mul_i32 s49, s48, 13
    s_lshr_b32 s49, s49, 6
    s_mul_i32 s53, s49, 5
    s_sub_u32 s48, s48, s53
    s_add_u32 s48, s48, s51
    s_cmp_ge_u32 s48, 54
    s_cbranch_scc1 K1_HSK4
    s_add_u32 s49, s49, s52
    s_mul_i32 s49, s49, 54
    s_add_u32 s49, s49, s48
    s_lshl_b32 s49, s49, 12
    s_and_b32 s47, s47, 3
    s_lshl_b32 s47, s47, 10
    s_add_u32 s49, s49, s47
    buffer_store_dwordx4 v[40:43], v1, s[16:19], s49 offen
K1_HSK4:
    s_add_u32 s47, s7, 40
    s_cmp_ge_u32 s47, 60
    s_cbranch_scc1 K1_END
    s_lshr_b32 s48, s47, 2
    s_mul_i32 s49, s48, 13
    s_lshr_b32 s49, s49, 6
    s_mul_i32 s53, s49, 5
    s_sub_u32 s48, s48, s53
    s_add_u32 s48, s48, s51
    s_cmp_ge_u32 s48, 54
    s_cbranch_scc1 K1_HSK5
    s_add_u32 s49, s49, s52
    s_mul_i32 s49, s49, 54
    s_add_u32 s49, s49, s48
    s_lshl_b32 s49, s49, 12
    s_and_b32 s47, s47, 3
    s_lshl_b32 s47, s47, 10
    s_add_u32 s49, s49, s47
    buffer_store_dwordx4 v[44:47], v1, s[16:19], s49 offen
K1_HSK5:
    s_add_u32 s47, s7, 48
    s_cmp_ge_u32 s47, 60
    s_cbranch_scc1 K1_END
    s_lshr_b32 s48, s47, 2
    s_mul_i32 s49, s48, 13
    s_lshr_b32 s49, s49, 6
    s_mul_i32 s53, s49, 5
    s_sub_u32 s48, s48, s53
    s_add_u32 s48, s48, s51
    s_cmp_ge_u32 s48, 54
    s_cbranch_scc1 K1_HSK6
    s_add_u32 s49, s49, s52
    s_mul_i32 s49, s49, 54
    s_add_u32 s49, s49, s48
    s_lshl_b32 s49, s49, 12
    s_and_b32 s47, s47, 3
    s_lshl_b32 s47, s47, 10
    s_add_u32 s49, s49, s47
    buffer_store_dwordx4 v[48:51], v1, s[16:19], s49 offen
K1_HSK6:
    s_add_u32 s47, s7, 56
    s_cmp_ge_u32 s47, 60
    s_cbranch_scc1 K1_END
    s_lshr_b32 s48, s47, 2
    s_mul_i32 s49, s48, 13
    s_lshr_b32 s49, s49, 6
    s_mul_i32 s53, s49, 5
    s_sub_u32 s48, s48, s53
    s_add_u32 s48, s48, s51
    s_cmp_ge_u32 s48, 54
    s_cbranch_scc1 K1_HSK7
    s_add_u32 s49, s49, s52
    s_mul_i32 s49, s49, 54
    s_add_u32 s49, s49, s48
    s_lshl_b32 s49, s49, 12
    s_and_b32 s47, s47, 3
    s_lshl_b32 s47, s47, 10
    s_add_u32 s49, s49, s47
    buffer_store_dwordx4 v[52:55], v1, s[16:19], s49 offen
K1_HSK7:
    s_branch K1_END
K1_KV:
    s_mov_b32 s55, 0
    s_add_u32 s96, s27, s55
    s_add_u32 s99, s30, s55
    s_add_u32 s97, s28, s55
    s_add_u32 s100, s31, s55
    s_add_u32 s98, s29, s55
    s_add_u32 s101, s32, s55
    s_mov_b32 m0, s96
    s_nop 0
    buffer_load_dwordx4 v6, s[8:11], s24 offen lds
    s_mov_b32 m0, s97
    s_nop 0
    buffer_load_dwordx4 v7, s[8:11], s24 offen lds
    s_mov_b32 m0, s98
    s_nop 0
    buffer_load_dwordx4 v8, s[8:11], s24 offen lds
    s_mov_b32 m0, s99
    s_nop 0
    buffer_load_dwordx4 v9, s[12:15], s25 offen lds
    s_mov_b32 m0, s100
    s_nop 0
    buffer_load_dwordx4 v10, s[12:15], s25 offen lds
    s_mov_b32 m0, s101
    s_nop 0
    buffer_load_dwordx4 v11, s[12:15], s25 offen lds
    s_add_u32 s24, s24, 128
    s_add_u32 s25, s25, s26
    s_add_u32 s55, s55, 45056
    s_cmp_eq_u32 s55, 135168
    s_cselect_b32 s55, 0, s55
    s_add_u32 s96, s27, s55
    s_add_u32 s99, s30, s55
    s_add_u32 s97, s28, s55
    s_add_u32 s100, s31, s55
    s_add_u32 s98, s29, s55
    s_add_u32 s101, s32, s55
    s_mov_b32 m0, s96
    s_nop 0
    buffer_load_dwordx4 v6, s[8:11], s24 offen lds
    s_mov_b32 m0, s97
    s_nop 0
    buffer_load_dwordx4 v7, s[8:11], s24 offen lds
    s_mov_b32 m0, s98
    s_nop 0
    buffer_load_dwordx4 v8, s[8:11], s24 offen lds
    s_mov_b32 m0, s99
    s_nop 0
    buffer_load_dwordx4 v9, s[12:15], s25 offen lds
    s_mov_b32 m0, s100
    s_nop 0
    buffer_load_dwordx4 v10, s[12:15], s25 offen lds
    s_mov_b32 m0, s101
    s_nop 0
    buffer_load_dwordx4 v11, s[12:15], s25 offen lds
    s_add_u32 s24, s24, 128
    s_add_u32 s25, s25, s26
    s_add_u32 s55, s55, 45056
    s_cmp_eq_u32 s55, 135168
    s_cselect_b32 s55, 0, s55
    s_add_u32 s96, s27, s55
    s_add_u32 s99, s30, s55
    s_add_u32 s97, s28, s55
    s_add_u32 s100, s31, s55
    s_add_u32 s98, s29, s55
    s_add_u32 s101, s32, s55
    s_mov_b32 m0, s96
    s_nop 0
    buffer_load_dwordx4 v6, s[8:11], s24 offen lds
    s_mov_b32 m0, s97
    s_nop 0
    buffer_load_dwordx4 v7, s[8:11], s24 offen lds
    s_mov_b32 m0, s98
    s_nop 0
    buffer_load_dwordx4 v8, s[8:11], s24 offen lds
    s_waitcnt vmcnt(9)
    s_barrier
    ds_read_b128 v[24:27], v12 offset:0
    ds_read_b128 v[28:31], v12 offset:2048
    ds_read_b128 v[32:35], v12 offset:4096
    ds_read_b64_tr_b16 v[36:37], v14 offset:24576
    ds_read_b64_tr_b16 v[38:39], v14 offset:25856
    ds_read_b64_tr_b16 v[40:41], v15 offset:24608
    ds_read_b64_tr_b16 v[42:43], v15 offset:25888
    ds_read_b64_tr_b16 v[44:45], v14 offset:24640
    ds_read_b64_tr_b16 v[46:47], v14 offset:25920
    ds_read_b64_tr_b16 v[48:49], v15 offset:24672
    ds_read_b64_tr_b16 v[50:51], v15 offset:25952
    ds_read_b64_tr_b16 v[52:53], v14 offset:24704
    ds_read_b64_tr_b16 v[54:55], v14 offset:25984
    s_mov_b32 s54, 0
K1_LOOP_kv:
    s_waitcnt lgkmcnt(0)
    s_cmp_lt_u32 s54, 8
    v_mfma_f32_16x16x32_bf16 v[88:91], v[24:27], v[36:39], v[88:91]
    ds_read_b128 v[56:59], v13 offset:0
    v_mfma_f32_16x16x32_bf16 v[108:111], v[28:31], v[36:39], v[108:111]
    ds_read_b128 v[60:63], v13 offset:2048
    v_mfma_f32_16x16x32_bf16 v[128:131], v[32:35], v[36:39], v[128:131]
    ds_read_b128 v[64:67], v13 offset:4096
    s_cbranch_scc0 K1Akv_3
    s_mov_b32 m0, s99
    s_nop 0
    buffer_load_dwordx4 v9, s[12:15], s25 offen lds
K1Akv_3:
    v_mfma_f32_16x16x32_bf16 v[92:95], v[24:27], v[40:43], v[92:95]
    ds_read_b64_tr_b16 v[68:69], v14 offset:34816
    v_mfma_f32_16x16x32_bf16 v[112:115], v[28:31], v[40:43], v[112:115]
    ds_read_b64_tr_b16 v[70:71], v14 offset:36096
    v_mfma_f32_16x16x32_bf16 v[132:135], v[32:35], v[40:43], v[132:135]
    ds_read_b64_tr_b16 v[72:73], v15 offset:34848
    v_mfma_f32_16x16x32_bf16 v[96:99], v[24:27], v[44:47], v[96:99]
    ds_read_b64_tr_b16 v[74:75], v15 offset:36128
    v_mfma_f32_16x16x32_bf16 v[116:119], v[28:31], v[44:47], v[116:119]
    ds_read_b64_tr_b16 v[76:77], v14 offset:34880
    s_cbranch_scc0 K1Akv_4
    s_mov_b32 m0, s100
    s_nop 0
    buffer_load_dwordx4 v10, s[12:15], s25 offen lds
K1Akv_4:
    v_mfma_f32_16x16x32_bf16 v[136:139], v[32:35], v[44:47], v[136:139]
    ds_read_b64_tr_b16 v[78:79], v14 offset:36160
    v_mfma_f32_16x16x32_bf16 v[100:103], v[24:27], v[48:51], v[100:103]
    ds_read_b64_tr_b16 v[80:81], v15 offset:34912
    v_mfma_f32_16x16x32_bf16 v[120:123], v[28:31], v[48:51], v[120:123]
    ds_read_b64_tr_b16 v[82:83], v15 offset:36192
    v_mfma_f32_16x16x32_bf16 v[140:143], v[32:35], v[48:51], v[140:143]
    ds_read_b64_tr_b16 v[84:85], v14 offset:34944
    v_mfma_f32_16x16x32_bf16 v[104:107], v[24:27], v[52:55], v[104:107]
    ds_read_b64_tr_b16 v[86:87], v14 offset:36224
    s_cbranch_scc0 K1Akv_5
    s_mov_b32 m0, s101
    s_nop 0
    buffer_load_dwordx4 v11, s[12:15], s25 offen lds
K1Akv_5:
    v_mfma_f32_16x16x32_bf16 v[124:127], v[28:31], v[52:55], v[124:127]
    v_mfma_f32_16x16x32_bf16 v[144:147], v[32:35], v[52:55], v[144:147]
    s_cbranch_scc0 K1_NOADV_kv
    s_add_u32 s24, s24, 128
    s_add_u32 s25, s25, s26
    s_add_u32 s55, s55, 45056
    s_cmp_eq_u32 s55, 135168
    s_cselect_b32 s55, 0, s55
    s_add_u32 s96, s27, s55
    s_add_u32 s99, s30, s55
    s_add_u32 s97, s28, s55
    s_add_u32 s100, s31, s55
    s_add_u32 s98, s29, s55
    s_add_u32 s101, s32, s55
K1_NOADV_kv:
    s_waitcnt lgkmcnt(0)
    s_cmp_eq_u32 s54, 9
    s_cbranch_scc1 K1_LAST_kv
    s_cmp_lt_u32 s54, 8
    s_cbranch_scc1 K1_W6_kv
    s_waitcnt vmcnt(0)
K1_W6_kv:
    s_waitcnt vmcnt(6)
    s_barrier
    s_add_u32 s59, s59, 1
    s_cmp_eq_u32 s59, 3
    s_cselect_b32 s59, 0, s59
    s_mov_b32 s47, 45056
    s_cselect_b32 s47, 4294877184, s47
    v_add_u32 v12, s47, v12
    v_add_u32 v13, s47, v13
    v_add_u32 v14, s47, v14
    v_add_u32 v15, s47, v15
    s_cmp_lt_u32 s54, 7
    v_mfma_f32_16x16x32_bf16 v[88:91], v[56:59], v[68:71], v[88:91]
    ds_read_b128 v[24:27], v12 offset:0
    v_mfma_f32_16x16x32_bf16 v[108:111], v[60:63], v[68:71], v[108:111]
    ds_read_b128 v[28:31], v12 offset:2048
    v_mfma_f32_16x16x32_bf16 v[128:131], v[64:67], v[68:71], v[128:131]
    ds_read_b128 v[32:35], v12 offset:4096
    s_cbranch_scc0 K1Bkv_0
    s_mov_b32 m0, s96
    s_nop 0
    buffer_load_dwordx4 v6, s[8:11], s24 offen lds
K1Bkv_0:
    v_mfma_f32_16x16x32_bf16 v[92:95], v[56:59], v[72:75], v[92:95]
    ds_read_b64_tr_b16 v[36:37], v14 offset:24576
    v_mfma_f32_16x16x32_bf16 v[112:115], v[60:63], v[72:75], v[112:115]
    ds_read_b64_tr_b16 v[38:39], v14 offset:25856
    v_mfma_f32_16x16x32_bf16 v[132:135], v[64:67], v[72:75], v[132:135]
    ds_read_b64_tr_b16 v[40:41], v15 offset:24608
    v_mfma_f32_16x16x32_bf16 v[96:99], v[56:59], v[76:79], v[96:99]
    ds_read_b64_tr_b16 v[42:43], v15 offset:25888
    v_mfma_f32_16x16x32_bf16 v[116:119], v[60:63], v[76:79], v[116:119]
    ds_read_b64_tr_b16 v[44:45], v14 offset:24640
    s_cbranch_scc0 K1Bkv_1
    s_mov_b32 m0, s97
    s_nop 0
    buffer_load_dwordx4 v7, s[8:11], s24 offen lds
K1Bkv_1:
    v_mfma_f32_16x16x32_bf16 v[136:139], v[64:67], v[76:79], v[136:139]
    ds_read_b64_tr_b16 v[46:47], v14 offset:25920
    v_mfma_f32_16x16x32_bf16 v[100:103], v[56:59], v[80:83], v[100:103]
    ds_read_b64_tr_b16 v[48:49], v15 offset:24672
    v_mfma_f32_16x16x32_bf16 v[120:123], v[60:63], v[80:83], v[120:123]
    ds_read_b64_tr_b16 v[50:51], v15 offset:25952
    v_mfma_f32_16x16x32_bf16 v[140:143], v[64:67], v[80:83], v[140:143]
    ds_read_b64_tr_b16 v[52:53], v14 offset:24704
    v_mfma_f32_16x16x32_bf16 v[104:107], v[56:59], v[84:87], v[104:107]
    ds_read_b64_tr_b16 v[54:55], v14 offset:25984
    s_cbranch_scc0 K1Bkv_2
    s_mov_b32 m0, s98
    s_nop 0
    buffer_load_dwordx4 v8, s[8:11], s24 offen lds
K1Bkv_2:
    v_mfma_f32_16x16x32_bf16 v[124:127], v[60:63], v[84:87], v[124:127]
    v_mfma_f32_16x16x32_bf16 v[144:147], v[64:67], v[84:87], v[144:147]
    s_add_u32 s54, s54, 1
    s_branch K1_LOOP_kv
K1_LAST_kv:
    v_mfma_f32_16x16x32_bf16 v[88:91], v[56:59], v[68:71], v[88:91]
    v_mfma_f32_16x16x32_bf16 v[108:111], v[60:63], v[68:71], v[108:111]
    v_mfma_f32_16x16x32_bf16 v[128:131], v[64:67], v[68:71], v[128:131]
    v_mfma_f32_16x16x32_bf16 v[92:95], v[56:59], v[72:75], v[92:95]
    v_mfma_f32_16x16x32_bf16 v[112:115], v[60:63], v[72:75], v[112:115]
    v_mfma_f32_16x16x32_bf16 v[132:135], v[64:67], v[72:75], v[132:135]
    v_mfma_f32_16x16x32_bf16 v[96:99], v[56:59], v[76:79], v[96:99]
    v_mfma_f32_16x16x32_bf16 v[116:119], v[60:63], v[76:79], v[116:119]
    v_mfma_f32_16x16x32_bf16 v[136:139], v[64:67], v[76:79], v[136:139]
    v_mfma_f32_16x16x32_bf16 v[100:103], v[56:59], v[80:83], v[100:103]
    v_mfma_f32_16x16x32_bf16 v[120:123], v[60:63], v[80:83], v[120:123]
    v_mfma_f32_16x16x32_bf16 v[140:143], v[64:67], v[80:83], v[140:143]
    v_mfma_f32_16x16x32_bf16 v[104:107], v[56:59], v[84:87], v[104:107]
    v_mfma_f32_16x16x32_bf16 v[124:127], v[60:63], v[84:87], v[124:127]
    v_mfma_f32_16x16x32_bf16 v[144:147], v[64:67], v[84:87], v[144:147]
    s_nop 7
    s_nop 7
    s_and_b32 s47, s7, 3
    s_mul_i32 s49, s47, 48
    s_mul_i32 s51, s4, 192
    s_add_u32 s49, s49, s51
    s_mov_b32 s51, 1069066811
    s_mov_b32 s52, 897988541
    v_mov_b32 v24, 0
    v_mov_b32 v25, 0
    v_mov_b32 v26, 0
    v_mov_b32 v27, 0
    v_mov_b32 v28, 0
    v_mov_b32 v29, 0
    v_mov_b32 v30, 0
    v_mov_b32 v31, 0
    v_mov_b32 v32, 0
    v_mov_b32 v33, 0
    v_mov_b32 v34, 0
    v_mov_b32 v35, 0
    v_mov_b32 v36, 0
    v_mov_b32 v37, 0
    v_mov_b32 v38, 0
    v_mov_b32 v39, 0
    v_mov_b32 v40, 0
    v_mov_b32 v41, 0
    v_mov_b32 v42, 0
    v_mov_b32 v43, 0
    v_mov_b32 v44, 0
    v_mov_b32 v45, 0
    v_mov_b32 v46, 0
    v_mov_b32 v47, 0
    v_mov_b32 v48, 0
    v_mov_b32 v49, 0
    v_mov_b32 v50, 0
    v_mov_b32 v51, 0
    v_mov_b32 v52, 0
    v_mov_b32 v53, 0
    v_mov_b32 v54, 0
    v_mov_b32 v55, 0
    v_mov_b32 v56, 0
    v_mov_b32 v57, 0
    v_mov_b32 v58, 0
    v_mov_b32 v59, 0
    v_mov_b32 v60, 0
    v_mov_b32 v61, 0
    v_mov_b32 v62, 0
    v_mov_b32 v63, 0
    v_mov_b32 v64, 0x3f803f80
    v_mov_b32 v65, 0x3f803f80
    v_cmp_gt_u32 s[54:55], 8, v4
    s_mov_b32 s96, 1069066811
    s_mov_b32 s97, 1069066811
    s_mov_b32 s98, 897988541
    s_mov_b32 s99, 897988541
    s_add_u32 s47, s49, 0
    s_cmp_ge_u32 s47, 2048
    s_cbranch_scc1 K1_KV_RED
    v_min_f32 v148, 0, v88
    v_min_f32 v149, 0, v89
    v_min_f32 v150, 0, v90
    v_min_f32 v151, 0, v91
    v_min_f32 v152, 0, v92
    v_min_f32 v153, 0, v93
    v_min_f32 v154, 0, v94
    v_min_f32 v155, 0, v95
    v_pk_mul_f32 v[148:149], v[148:149], s[96:97]
    v_pk_mul_f32 v[150:151], v[150:151], s[96:97]
    v_pk_mul_f32 v[152:153], v[152:153], s[96:97]
    v_pk_mul_f32 v[154:155], v[154:155], s[96:97]
    v_exp_f32 v148, v148
    v_exp_f32 v149, v149
    v_exp_f32 v150, v150
    v_exp_f32 v151, v151
    v_exp_f32 v152, v152
    v_exp_f32 v153, v153
    v_exp_f32 v154, v154
    v_exp_f32 v155, v155
    v_max_f32 v156, 0, v88
    v_max_f32 v157, 0, v89
    v_max_f32 v158, 0, v90
    v_max_f32 v159, 0, v91
    v_max_f32 v160, 0, v92
    v_max_f32 v161, 0, v93
    v_max_f32 v162, 0, v94
    v_max_f32 v163, 0, v95
    v_pk_add_f32 v[156:157], v[156:157], s[98:99]
    v_pk_add_f32 v[158:159], v[158:159], s[98:99]
    v_pk_add_f32 v[160:161], v[160:161], s[98:99]
    v_pk_add_f32 v[162:163], v[162:163], s[98:99]
    v_pk_add_f32 v[148:149], v[148:149], v[156:157]
    v_pk_add_f32 v[150:151], v[150:151], v[158:159]
    v_pk_add_f32 v[152:153], v[152:153], v[160:161]
    v_pk_add_f32 v[154:155], v[154:155], v[162:163]
    v_min_f32 v76, 0, v96
    v_min_f32 v77, 0, v97
    v_min_f32 v78, 0, v98
    v_min_f32 v79, 0, v99
    v_pk_mul_f32 v[76:77], v[76:77], s[96:97]
    v_pk_mul_f32 v[78:79], v[78:79], s[96:97]
    v_exp_f32 v76, v76
    v_exp_f32 v77, v77
    v_exp_f32 v78, v78
    v_exp_f32 v79, v79
    v_max_f32 v80, 0, v96
    v_max_f32 v81, 0, v97
    v_max_f32 v82, 0, v98
    v_max_f32 v83, 0, v99
    v_pk_add_f32 v[80:81], v[80:81], s[98:99]
    v_pk_add_f32 v[82:83], v[82:83], s[98:99]
    v_pk_add_f32 v[76:77], v[76:77], v[80:81]
    v_pk_add_f32 v[78:79], v[78:79], v[82:83]
    v_cndmask_b32 v76, v96, v76, s[54:55]
    v_cndmask_b32 v77, v97, v77, s[54:55]
    v_cndmask_b32 v78, v98, v78, s[54:55]
    v_cndmask_b32 v79, v99, v79, s[54:55]
    v_cvt_pk_bf16_f32 v66, v148, v149
    v_cvt_pk_bf16_f32 v67, v150, v151
    v_cvt_pk_bf16_f32 v68, v152, v153
    v_cvt_pk_bf16_f32 v69, v154, v155
    v_cvt_pk_bf16_f32 v70, v76, v77
    v_cvt_pk_bf16_f32 v71, v78, v79
    v_cvt_pk_bf16_f32 v72, v100, v101
    v_cvt_pk_bf16_f32 v73, v102, v103
    v_cvt_pk_bf16_f32 v74, v104, v105
    v_cvt_pk_bf16_f32 v75, v106, v107
    s_nop 1
    v_mfma_f32_16x16x16_bf16 v[24:27], v[66:67], v[70:71], v[24:27]
    v_mfma_f32_16x16x16_bf16 v[28:31], v[66:67], v[72:73], v[28:31]
    v_mfma_f32_16x16x16_bf16 v[32:35], v[68:69], v[70:71], v[32:35]
    v_mfma_f32_16x16x16_bf16 v[36:39], v[68:69], v[72:73], v[36:39]
    v_mfma_f32_16x16x16_bf16 v[40:43], v[68:69], v[74:75], v[40:43]
    v_mfma_f32_16x16x16_bf16 v[44:47], v[70:71], v[72:73], v[44:47]
    v_mfma_f32_16x16x16_bf16 v[48:51], v[70:71], v[74:75], v[48:51]
    v_mfma_f32_16x16x16_bf16 v[52:55], v[66:67], v[64:65], v[52:55]
    v_mfma_f32_16x16x16_bf16 v[56:59], v[68:69], v[64:65], v[56:59]
    v_mfma_f32_16x16x16_bf16 v[60:63], v[70:71], v[64:65], v[60:63]
    s_nop 7
    s_add_u32 s47, s49, 16
    s_cmp_ge_u32 s47, 2048
    s_cbranch_scc1 K1_KV_RED
    v_min_f32 v148, 0, v108
    v_min_f32 v149, 0, v109
    v_min_f32 v150, 0, v110
    v_min_f32 v151, 0, v111
    v_min_f32 v152, 0, v112
    v_min_f32 v153, 0, v113
    v_min_f32 v154, 0, v114
    v_min_f32 v155, 0, v115
    v_pk_mul_f32 v[148:149], v[148:149], s[96:97]
    v_pk_mul_f32 v[150:151], v[150:151], s[96:97]
    v_pk_mul_f32 v[152:153], v[152:153], s[96:97]
    v_pk_mul_f32 v[154:155], v[154:155], s[96:97]
    v_exp_f32 v148, v148
    v_exp_f32 v149, v149
    v_exp_f32 v150, v150
    v_exp_f32 v151, v151
    v_exp_f32 v152, v152
    v_exp_f32 v153, v153
    v_exp_f32 v154, v154
    v_exp_f32 v155, v155
    v_max_f32 v156, 0, v108
    v_max_f32 v157, 0, v109
    v_max_f32 v158, 0, v110
    v_max_f32 v159, 0, v111
    v_max_f32 v160, 0, v112
    v_max_f32 v161, 0, v113
    v_max_f32 v162, 0, v114
    v_max_f32 v163, 0, v115
    v_pk_add_f32 v[156:157], v[156:157], s[98:99]
    v_pk_add_f32 v[158:159], v[158:159], s[98:99]
    v_pk_add_f32 v[160:161], v[160:161], s[98:99]
    v_pk_add_f32 v[162:163], v[162:163], s[98:99]
    v_pk_add_f32 v[148:149], v[148:149], v[156:157]
    v_pk_add_f32 v[150:151], v[150:151], v[158:159]
    v_pk_add_f32 v[152:153], v[152:153], v[160:161]
    v_pk_add_f32 v[154:155], v[154:155], v[162:163]
    v_min_f32 v76, 0, v116
    v_min_f32 v77, 0, v117
    v_min_f32 v78, 0, v118
    v_min_f32 v79, 0, v119
    v_pk_mul_f32 v[76:77], v[76:77], s[96:97]
    v_pk_mul_f32 v[78:79], v[78:79], s[96:97]
    v_exp_f32 v76, v76
    v_exp_f32 v77, v77
    v_exp_f32 v78, v78
    v_exp_f32 v79, v79
    v_max_f32 v80, 0, v116
    v_max_f32 v81, 0, v117
    v_max_f32 v82, 0, v118
    v_max_f32 v83, 0, v119
    v_pk_add_f32 v[80:81], v[80:81], s[98:99]
    v_pk_add_f32 v[82:83], v[82:83], s[98:99]
    v_pk_add_f32 v[76:77], v[76:77], v[80:81]
    v_pk_add_f32 v[78:79], v[78:79], v[82:83]
    v_cndmask_b32 v76, v116, v76, s[54:55]
    v_cndmask_b32 v77, v117, v77, s[54:55]
    v_cndmask_b32 v78, v118, v78, s[54:55]
    v_cndmask_b32 v79, v119, v79, s[54:55]
    v_cvt_pk_bf16_f32 v66, v148, v149
    v_cvt_pk_bf16_f32 v67, v150, v151
    v_cvt_pk_bf16_f32 v68, v152, v153
    v_cvt_pk_bf16_f32 v69, v154, v155
    v_cvt_pk_bf16_f32 v70, v76, v77
    v_cvt_pk_bf16_f32 v71, v78, v79
    v_cvt_pk_bf16_f32 v72, v120, v121
    v_cvt_pk_bf16_f32 v73, v122, v123
    v_cvt_pk_bf16_f32 v74, v124, v125
    v_cvt_pk_bf16_f32 v75, v126, v127
    s_nop 1
    v_mfma_f32_16x16x16_bf16 v[24:27], v[66:67], v[70:71], v[24:27]
    v_mfma_f32_16x16x16_bf16 v[28:31], v[66:67], v[72:73], v[28:31]
    v_mfma_f32_16x16x16_bf16 v[32:35], v[68:69], v[70:71], v[32:35]
    v_mfma_f32_16x16x16_bf16 v[36:39], v[68:69], v[72:73], v[36:39]
    v_mfma_f32_16x16x16_bf16 v[40:43], v[68:69], v[74:75], v[40:43]
    v_mfma_f32_16x16x16_bf16 v[44:47], v[70:71], v[72:73], v[44:47]
    v_mfma_f32_16x16x16_bf16 v[48:51], v[70:71], v[74:75], v[48:51]
    v_mfma_f32_16x16x16_bf16 v[52:55], v[66:67], v[64:65], v[52:55]
    v_mfma_f32_16x16x16_bf16 v[56:59], v[68:69], v[64:65], v[56:59]
    v_mfma_f32_16x16x16_bf16 v[60:63], v[70:71], v[64:65], v[60:63]
    s_nop 7
    s_add_u32 s47, s49, 32
    s_cmp_ge_u32 s47, 2048
    s_cbranch_scc1 K1_KV_RED
    v_min_f32 v148, 0, v128
    v_min_f32 v149, 0, v129
    v_min_f32 v150, 0, v130
    v_min_f32 v151, 0, v131
    v_min_f32 v152, 0, v132
    v_min_f32 v153, 0, v133
    v_min_f32 v154, 0, v134
    v_min_f32 v155, 0, v135
    v_pk_mul_f32 v[148:149], v[148:149], s[96:97]
    v_pk_mul_f32 v[150:151], v[150:151], s[96:97]
    v_pk_mul_f32 v[152:153], v[152:153], s[96:97]
    v_pk_mul_f32 v[154:155], v[154:155], s[96:97]
    v_exp_f32 v148, v148
    v_exp_f32 v149, v149
    v_exp_f32 v150, v150
    v_exp_f32 v151, v151
    v_exp_f32 v152, v152
    v_exp_f32 v153, v153
    v_exp_f32 v154, v154
    v_exp_f32 v155, v155
    v_max_f32 v156, 0, v128
    v_max_f32 v157, 0, v129
    v_max_f32 v158, 0, v130
    v_max_f32 v159, 0, v131
    v_max_f32 v160, 0, v132
    v_max_f32 v161, 0, v133
    v_max_f32 v162, 0, v134
    v_max_f32 v163, 0, v135
    v_pk_add_f32 v[156:157], v[156:157], s[98:99]
    v_pk_add_f32 v[158:159], v[158:159], s[98:99]
    v_pk_add_f32 v[160:161], v[160:161], s[98:99]
    v_pk_add_f32 v[162:163], v[162:163], s[98:99]
    v_pk_add_f32 v[148:149], v[148:149], v[156:157]
    v_pk_add_f32 v[150:151], v[150:151], v[158:159]
    v_pk_add_f32 v[152:153], v[152:153], v[160:161]
    v_pk_add_f32 v[154:155], v[154:155], v[162:163]
    v_min_f32 v76, 0, v136
    v_min_f32 v77, 0, v137
    v_min_f32 v78, 0, v138
    v_min_f32 v79, 0, v139
    v_pk_mul_f32 v[76:77], v[76:77], s[96:97]
    v_pk_mul_f32 v[78:79], v[78:79], s[96:97]
    v_exp_f32 v76, v76
    v_exp_f32 v77, v77
    v_exp_f32 v78, v78
    v_exp_f32 v79, v79
    v_max_f32 v80, 0, v136
    v_max_f32 v81, 0, v137
    v_max_f32 v82, 0, v138
    v_max_f32 v83, 0, v139
    v_pk_add_f32 v[80:81], v[80:81], s[98:99]
    v_pk_add_f32 v[82:83], v[82:83], s[98:99]
    v_pk_add_f32 v[76:77], v[76:77], v[80:81]
    v_pk_add_f32 v[78:79], v[78:79], v[82:83]
    v_cndmask_b32 v76, v136, v76, s[54:55]
    v_cndmask_b32 v77, v137, v77, s[54:55]
    v_cndmask_b32 v78, v138, v78, s[54:55]
    v_cndmask_b32 v79, v139, v79, s[54:55]
    v_cvt_pk_bf16_f32 v66, v148, v149
    v_cvt_pk_bf16_f32 v67, v150, v151
    v_cvt_pk_bf16_f32 v68, v152, v153
    v_cvt_pk_bf16_f32 v69, v154, v155
    v_cvt_pk_bf16_f32 v70, v76, v77
    v_cvt_pk_bf16_f32 v71, v78, v79
    v_cvt_pk_bf16_f32 v72, v140, v141
    v_cvt_pk_bf16_f32 v73, v142, v143
    v_cvt_pk_bf16_f32 v74, v144, v145
    v_cvt_pk_bf16_f32 v75, v146, v147
    s_nop 1
    v_mfma_f32_16x16x16_bf16 v[24:27], v[66:67], v[70:71], v[24:27]
    v_mfma_f32_16x16x16_bf16 v[28:31], v[66:67], v[72:73], v[28:31]
    v_mfma_f32_16x16x16_bf16 v[32:35], v[68:69], v[70:71], v[32:35]
    v_mfma_f32_16x16x16_bf16 v[36:39], v[68:69], v[72:73], v[36:39]
    v_mfma_f32_16x16x16_bf16 v[40:43], v[68:69], v[74:75], v[40:43]
    v_mfma_f32_16x16x16_bf16 v[44:47], v[70:71], v[72:73], v[44:47]
    v_mfma_f32_16x16x16_bf16 v[48:51], v[70:71], v[74:75], v[48:51]
    v_mfma_f32_16x16x16_bf16 v[52:55], v[66:67], v[64:65], v[52:55]
    v_mfma_f32_16x16x16_bf16 v[56:59], v[68:69], v[64:65], v[56:59]
    v_mfma_f32_16x16x16_bf16 v[60:63], v[70:71], v[64:65], v[60:63]
    s_nop 7
K1_KV_RED:
    s_nop 7
    s_nop 7
    s_barrier
    s_mul_i32 s47, s7, 10240
    v_lshlrev_b32 v1, 4, v2
    v_add_u32 v5, s47, v1
    ds_write_b128 v5, v[24:27] offset:0
    ds_write_b128 v5, v[28:31] offset:1024
    ds_write_b128 v5, v[32:35] offset:2048
    ds_write_b128 v5, v[36:39] offset:3072
    ds_write_b128 v5, v[40:43] offset:4096
    ds_write_b128 v5, v[44:47] offset:5120
    ds_write_b128 v5, v[48:51] offset:6144
    ds_write_b128 v5, v[52:55] offset:7168
    ds_write_b128 v5, v[56:59] offset:8192
    ds_write_b128 v5, v[60:63] offset:9216
    s_waitcnt lgkmcnt(0)
    s_barrier
    s_mul_i32 s51, s4, 53760
    s_mul_i32 s52, s5, 6400
    s_add_u32 s52, s52, s51
    s_mul_i32 s53, s5, 320
    s_add_u32 s53, s53, s51
    s_add_u32 s53, s53, 44800
    v_mov_b32 v30, 0x7fffffff
    v_add_u32 v8, 0, v0
    v_cmp_gt_u32 vcc, 1600, v8
    s_nop 1
    s_mov_b64 s[56:57], vcc
    v_mul_u32_u24 v9, 41944, v8
    v_lshrrev_b32 v9, 24, v9
    v_mul_u32_u24 v10, 400, v9
    v_sub_u32 v10, v8, v10
    v_mul_u32_u24 v11, 3277, v10
    v_lshrrev_b32 v11, 16, v11
    v_mul_u32_u24 v12, 20, v11
    v_sub_u32 v12, v10, v12
    v_and_b32 v13, 1, v9
    v_mul_u32_u24 v13, 20, v13
    v_add_u32 v11, v11, v13
    v_add_u32 v12, v12, v13
    v_add_u32 v12, 40, v12
    v_lshrrev_b32 v9, 1, v9
    v_subrev_u32 v14, 1600, v8
    v_cmp_le_u32 vcc, 40, v14
    v_mov_b32 v15, 0
    v_mov_b32 v16, 1
    v_cndmask_b32 v15, v15, v16, vcc
    v_mul_u32_u24 v16, 40, v15
    v_sub_u32 v14, v14, v16
    v_cndmask_b32 v9, v15, v9, s[56:57]
    v_cndmask_b32 v11, v14, v11, s[56:57]
    v_lshrrev_b32 v13, 4, v11
    v_lshlrev_b32 v14, 1, v13
    v_lshrrev_b32 v15, 4, v12
    v_add_u32 v14, v14, v15
    v_subrev_u32 v14, 2, v14
    v_add_u32 v13, 7, v13
    v_cndmask_b32 v13, v13, v14, s[56:57]
    v_and_b32 v14, 15, v12
    v_cndmask_b32 v14, 0, v14, s[56:57]
    v_bfe_u32 v15, v11, 2, 2
    v_lshlrev_b32 v15, 4, v15
    v_add_u32 v14, v14, v15
    v_lshlrev_b32 v14, 4, v14
    v_and_b32 v15, 3, v11
    v_lshlrev_b32 v15, 2, v15
    v_add_u32 v14, v14, v15
    v_lshlrev_b32 v13, 10, v13
    v_add_u32 v14, v14, v13
    v_mul_u32_u24 v9, 40960, v9
    v_add_u32 v14, v14, v9
    v_and_b32 v14, 0xffff, v14
    ds_read_b32 v20, v14 offset:0
    ds_read_b32 v21, v14 offset:10240
    ds_read_b32 v22, v14 offset:20480
    ds_read_b32 v23, v14 offset:30720
    v_lshlrev_b32 v15, 2, v8
    v_add_u32 v16, s52, v15
    v_add_u32 v17, s53, v15
    v_cndmask_b32 v16, v17, v16, s[56:57]
    s_waitcnt lgkmcnt(0)
    v_add_f32 v20, v20, v21
    v_add_f32 v22, v22, v23
    v_add_f32 v20, v20, v22
    buffer_store_dword v20, v16, s[16:19], 0 offen
    v_add_u32 v8, 512, v0
    v_cmp_gt_u32 vcc, 1600, v8
    s_nop 1
    s_mov_b64 s[56:57], vcc
    v_mul_u32_u24 v9, 41944, v8
    v_lshrrev_b32 v9, 24, v9
    v_mul_u32_u24 v10, 400, v9
    v_sub_u32 v10, v8, v10
    v_mul_u32_u24 v11, 3277, v10
    v_lshrrev_b32 v11, 16, v11
    v_mul_u32_u24 v12, 20, v11
    v_sub_u32 v12, v10, v12
    v_and_b32 v13, 1, v9
    v_mul_u32_u24 v13, 20, v13
    v_add_u32 v11, v11, v13
    v_add_u32 v12, v12, v13
    v_add_u32 v12, 40, v12
    v_lshrrev_b32 v9, 1, v9
    v_subrev_u32 v14, 1600, v8
    v_cmp_le_u32 vcc, 40, v14
    v_mov_b32 v15, 0
    v_mov_b32 v16, 1
    v_cndmask_b32 v15, v15, v16, vcc
    v_mul_u32_u24 v16, 40, v15
    v_sub_u32 v14, v14, v16
    v_cndmask_b32 v9, v15, v9, s[56:57]
    v_cndmask_b32 v11, v14, v11, s[56:57]
    v_lshrrev_b32 v13, 4, v11
    v_lshlrev_b32 v14, 1, v13
    v_lshrrev_b32 v15, 4, v12
    v_add_u32 v14, v14, v15
    v_subrev_u32 v14, 2, v14
    v_add_u32 v13, 7, v13
    v_cndmask_b32 v13, v13, v14, s[56:57]
    v_and_b32 v14, 15, v12
    v_cndmask_b32 v14, 0, v14, s[56:57]
    v_bfe_u32 v15, v11, 2, 2
    v_lshlrev_b32 v15, 4, v15
    v_add_u32 v14, v14, v15
    v_lshlrev_b32 v14, 4, v14
    v_and_b32 v15, 3, v11
    v_lshlrev_b32 v15, 2, v15
    v_add_u32 v14, v14, v15
    v_lshlrev_b32 v13, 10, v13
    v_add_u32 v14, v14, v13
    v_mul_u32_u24 v9, 40960, v9
    v_add_u32 v14, v14, v9
    v_and_b32 v14, 0xffff, v14
    ds_read_b32 v20, v14 offset:0
    ds_read_b32 v21, v14 offset:10240
    ds_read_b32 v22, v14 offset:20480
    ds_read_b32 v23, v14 offset:30720
    v_lshlrev_b32 v15, 2, v8
    v_add_u32 v16, s52, v15
    v_add_u32 v17, s53, v15
    v_cndmask_b32 v16, v17, v16, s[56:57]
    s_waitcnt lgkmcnt(0)
    v_add_f32 v20, v20, v21
    v_add_f32 v22, v22, v23
    v_add_f32 v20, v20, v22
    buffer_store_dword v20, v16, s[16:19], 0 offen
    v_add_u32 v8, 1024, v0
    v_cmp_gt_u32 vcc, 1600, v8
    s_nop 1
    s_mov_b64 s[56:57], vcc
    v_mul_u32_u24 v9, 41944, v8
    v_lshrrev_b32 v9, 24, v9
    v_mul_u32_u24 v10, 400, v9
    v_sub_u32 v10, v8, v10
    v_mul_u32_u24 v11, 3277, v10
    v_lshrrev_b32 v11, 16, v11
    v_mul_u32_u24 v12, 20, v11
    v_sub_u32 v12, v10, v12
    v_and_b32 v13, 1, v9
    v_mul_u32_u24 v13, 20, v13
    v_add_u32 v11, v11, v13
    v_add_u32 v12, v12, v13
    v_add_u32 v12, 40, v12
    v_lshrrev_b32 v9, 1, v9
    v_subrev_u32 v14, 1600, v8
    v_cmp_le_u32 vcc, 40, v14
    v_mov_b32 v15, 0
    v_mov_b32 v16, 1
    v_cndmask_b32 v15, v15, v16, vcc
    v_mul_u32_u24 v16, 40, v15
    v_sub_u32 v14, v14, v16
    v_cndmask_b32 v9, v15, v9, s[56:57]
    v_cndmask_b32 v11, v14, v11, s[56:57]
    v_lshrrev_b32 v13, 4, v11
    v_lshlrev_b32 v14, 1, v13
    v_lshrrev_b32 v15, 4, v12
    v_add_u32 v14, v14, v15
    v_subrev_u32 v14, 2, v14
    v_add_u32 v13, 7, v13
    v_cndmask_b32 v13, v13, v14, s[56:57]
    v_and_b32 v14, 15, v12
    v_cndmask_b32 v14, 0, v14, s[56:57]
    v_bfe_u32 v15, v11, 2, 2
    v_lshlrev_b32 v15, 4, v15
    v_add_u32 v14, v14, v15
    v_lshlrev_b32 v14, 4, v14
    v_and_b32 v15, 3, v11
    v_lshlrev_b32 v15, 2, v15
    v_add_u32 v14, v14, v15
    v_lshlrev_b32 v13, 10, v13
    v_add_u32 v14, v14, v13
    v_mul_u32_u24 v9, 40960, v9
    v_add_u32 v14, v14, v9
    v_and_b32 v14, 0xffff, v14
    ds_read_b32 v20, v14 offset:0
    ds_read_b32 v21, v14 offset:10240
    ds_read_b32 v22, v14 offset:20480
    ds_read_b32 v23, v14 offset:30720
    v_lshlrev_b32 v15, 2, v8
    v_add_u32 v16, s52, v15
    v_add_u32 v17, s53, v15
    v_cndmask_b32 v16, v17, v16, s[56:57]
    s_waitcnt lgkmcnt(0)
    v_add_f32 v20, v20, v21
    v_add_f32 v22, v22, v23
    v_add_f32 v20, v20, v22
    buffer_store_dword v20, v16, s[16:19], 0 offen
    v_add_u32 v8, 1536, v0
    v_cmp_gt_u32 vcc, 1600, v8
    s_nop 1
    s_mov_b64 s[56:57], vcc
    v_mul_u32_u24 v9, 41944, v8
    v_lshrrev_b32 v9, 24, v9
    v_mul_u32_u24 v10, 400, v9
    v_sub_u32 v10, v8, v10
    v_mul_u32_u24 v11, 3277, v10
    v_lshrrev_b32 v11, 16, v11
    v_mul_u32_u24 v12, 20, v11
    v_sub_u32 v12, v10, v12
    v_and_b32 v13, 1, v9
    v_mul_u32_u24 v13, 20, v13
    v_add_u32 v11, v11, v13
    v_add_u32 v12, v12, v13
    v_add_u32 v12, 40, v12
    v_lshrrev_b32 v9, 1, v9
    v_subrev_u32 v14, 1600, v8
    v_cmp_le_u32 vcc, 40, v14
    v_mov_b32 v15, 0
    v_mov_b32 v16, 1
    v_cndmask_b32 v15, v15, v16, vcc
    v_mul_u32_u24 v16, 40, v15
    v_sub_u32 v14, v14, v16
    v_cndmask_b32 v9, v15, v9, s[56:57]
    v_cndmask_b32 v11, v14, v11, s[56:57]
    v_lshrrev_b32 v13, 4, v11
    v_lshlrev_b32 v14, 1, v13
    v_lshrrev_b32 v15, 4, v12
    v_add_u32 v14, v14, v15
    v_subrev_u32 v14, 2, v14
    v_add_u32 v13, 7, v13
    v_cndmask_b32 v13, v13, v14, s[56:57]
    v_and_b32 v14, 15, v12
    v_cndmask_b32 v14, 0, v14, s[56:57]
    v_bfe_u32 v15, v11, 2, 2
    v_lshlrev_b32 v15, 4, v15
    v_add_u32 v14, v14, v15
    v_lshlrev_b32 v14, 4, v14
    v_and_b32 v15, 3, v11
    v_lshlrev_b32 v15, 2, v15
    v_add_u32 v14, v14, v15
    v_lshlrev_b32 v13, 10, v13
    v_add_u32 v14, v14, v13
    v_mul_u32_u24 v9, 40960, v9
    v_add_u32 v14, v14, v9
    v_and_b32 v14, 0xffff, v14
    ds_read_b32 v20, v14 offset:0
    ds_read_b32 v21, v14 offset:10240
    ds_read_b32 v22, v14 offset:20480
    ds_read_b32 v23, v14 offset:30720
    v_lshlrev_b32 v15, 2, v8
    v_add_u32 v16, s52, v15
    v_add_u32 v17, s53, v15
    v_cndmask_b32 v16, v17, v16, s[56:57]
    v_cmp_gt_u32 vcc, 1680, v8
    s_nop 1
    v_cndmask_b32 v16, v30, v16, vcc
    s_waitcnt lgkmcnt(0)
    v_add_f32 v20, v20, v21
    v_add_f32 v22, v22, v23
    v_add_f32 v20, v20, v22
    buffer_store_dword v20, v16, s[16:19], 0 offen
K1_END:
K1_EXIT:
    s_endpgm
.section .rodata,"a"
.p2align 6
.amdhsa_kernel k1_gemm_kernel
  .amdhsa_next_free_vgpr 168
  .amdhsa_next_free_sgpr 102
  .amdhsa_accum_offset 168
  .amdhsa_group_segment_fixed_size 0
  .amdhsa_kernarg_size 96
  .amdhsa_user_sgpr_count 2
  .amdhsa_user_sgpr_kernarg_segment_ptr 1
  .amdhsa_system_sgpr_workgroup_id_x 1
.end_amdhsa_kernel
.text
.globl k2_small_kernel
.p2align 8
.type k2_small_kernel,@function
k2_small_kernel:
    s_cmp_ge_u32 s2, 256
    s_cbranch_scc1 K2_EXIT
    s_load_dwordx2 s[40:41], s[0:1], 0
    s_load_dwordx2 s[42:43], s[0:1], 16
    s_load_dwordx2 s[52:53], s[0:1], 48
    s_load_dwordx2 s[44:45], s[0:1], 64
    s_load_dwordx2 s[46:47], s[0:1], 88
    v_lshrrev_b32 v9, 6, v0
    v_and_b32 v10, 63, v0
    v_lshlrev_b32 v10, 4, v10
    v_readfirstlane_b32 s3, v9
    s_waitcnt lgkmcnt(0)
    s_mov_b32 s24, s40
    s_and_b32 s25, s41, 0xffff
    s_mov_b32 s26, 2621440
    s_mov_b32 s27, 0x00020000
    s_mov_b32 s12, s42
    s_and_b32 s13, s43, 0xffff
    s_mov_b32 s14, 819200
    s_mov_b32 s15, 0x00020000
    s_mov_b32 s28, s44
    s_and_b32 s29, s45, 0xffff
    s_mov_b32 s30, 1280
    s_mov_b32 s31, 0x00020000
    s_mov_b32 s88, s52
    s_and_b32 s89, s53, 0xffff
    s_mov_b32 s90, 2211840
    s_mov_b32 s91, 0x00020000
    s_add_u32 s48, s46, 13148160
    s_addc_u32 s49, s47, 0
    s_mov_b32 s8, s48
    s_and_b32 s9, s49, 0xffff
    s_mov_b32 s10, 591360
    s_mov_b32 s11, 0x00020000
    s_add_u32 s48, s46, 7077888
    s_addc_u32 s49, s47, 0
    s_mov_b32 s16, s48
    s_and_b32 s17, s49, 0xffff
    s_mov_b32 s18, 2621440
    s_mov_b32 s19, 0x00020000
    s_add_u32 s48, s46, 9699328
    s_addc_u32 s49, s47, 0
    s_mov_b32 s20, s48
    s_and_b32 s21, s49, 0xffff
    s_mov_b32 s22, 2621440
    s_mov_b32 s23, 0x00020000
    s_add_u32 s48, s46, 12320768
    s_addc_u32 s49, s47, 0
    s_mov_b32 s32, s48
    s_and_b32 s33, s49, 0xffff
    s_mov_b32 s34, 819200
    s_mov_b32 s35, 0x00020000
    s_add_u32 s48, s46, 13139968
    s_addc_u32 s49, s47, 0
    s_mov_b32 s36, s48
    s_and_b32 s37, s49, 0xffff
    s_mov_b32 s38, 8192
    s_mov_b32 s39, 0x00020000
    s_add_u32 s48, s46, 13762560
    s_addc_u32 s49, s47, 0
    s_mov_b32 s84, s48
    s_and_b32 s85, s49, 0xffff
    s_mov_b32 s86, 2211840
    s_mov_b32 s87, 0x00020000
    s_lshr_b32 s4, s2, 3
    s_and_b32 s5, s2, 7
    v_lshlrev_b32 v8, 4, v0
    v_mov_b32 v12, 0x7fffffff
    v_add_u32 v11, 51200, v8
    v_cmp_gt_u32 vcc, 160, v0
    s_mul_i32 s6, s4, 1600
    v_add_u32 v13, s6, v8
    v_cndmask_b32 v11, v12, v11, vcc
    v_cmp_gt_u32 vcc, 100, v0
    s_nop 1
    v_cndmask_b32 v13, v12, v13, vcc
    s_cmp_ge_u32 s3, 3
    s_cbranch_scc1 K2_NOPART
    s_mov_b32 s50, 0
    buffer_load_dwordx4 v[20:23], v11, s[8:11], s50 offen
    s_mov_b32 s50, 53760
    buffer_load_dwordx4 v[24:27], v11, s[8:11], s50 offen
    s_mov_b32 s50, 107520
    buffer_load_dwordx4 v[28:31], v11, s[8:11], s50 offen
    s_mov_b32 s50, 161280
    buffer_load_dwordx4 v[32:35], v11, s[8:11], s50 offen
    s_mov_b32 s50, 215040
    buffer_load_dwordx4 v[36:39], v11, s[8:11], s50 offen
    s_mov_b32 s50, 268800
    buffer_load_dwordx4 v[40:43], v11, s[8:11], s50 offen
    s_mov_b32 s50, 322560
    buffer_load_dwordx4 v[44:47], v11, s[8:11], s50 offen
    s_mov_b32 s50, 376320
    buffer_load_dwordx4 v[48:51], v11, s[8:11], s50 offen
    s_mov_b32 s50, 430080
    buffer_load_dwordx4 v[52:55], v11, s[8:11], s50 offen
    s_mov_b32 s50, 483840
    buffer_load_dwordx4 v[56:59], v11, s[8:11], s50 offen
    s_mov_b32 s50, 537600
    buffer_load_dwordx4 v[60:63], v11, s[8:11], s50 offen
    s_cmp_ge_u32 s3, 2
    s_cbranch_scc1 K2_NOPART
    s_mov_b32 s50, 0
    buffer_load_dwordx4 v[180:183], v13, s[8:11], s50 offen
    s_mov_b32 s50, 53760
    buffer_load_dwordx4 v[184:187], v13, s[8:11], s50 offen
    s_mov_b32 s50, 107520
    buffer_load_dwordx4 v[188:191], v13, s[8:11], s50 offen
    s_mov_b32 s50, 161280
    buffer_load_dwordx4 v[192:195], v13, s[8:11], s50 offen
    s_mov_b32 s50, 215040
    buffer_load_dwordx4 v[196:199], v13, s[8:11], s50 offen
    s_mov_b32 s50, 268800
    buffer_load_dwordx4 v[200:203], v13, s[8:11], s50 offen
    s_mov_b32 s50, 322560
    buffer_load_dwordx4 v[204:207], v13, s[8:11], s50 offen
    s_mov_b32 s50, 376320
    buffer_load_dwordx4 v[208:211], v13, s[8:11], s50 offen
    s_mov_b32 s50, 430080
    buffer_load_dwordx4 v[212:215], v13, s[8:11], s50 offen
    s_mov_b32 s50, 483840
    buffer_load_dwordx4 v[216:219], v13, s[8:11], s50 offen
    s_mov_b32 s50, 537600
    buffer_load_dwordx4 v[220:223], v13, s[8:11], s50 offen
K2_NOPART:
    s_mul_i32 s6, s2, 10240
    s_add_u32 s7, s3, 0
    s_lshl_b32 s7, s7, 10
    s_add_u32 s50, s6, s7
    s_add_u32 m0, s7, 0
    s_nop 0
    buffer_load_dwordx4 v10, s[16:19], s50 offen lds
    s_add_u32 m0, s7, 10240
    s_nop 0
    buffer_load_dwordx4 v10, s[24:27], s50 offen lds
    s_cmp_ge_u32 s3, 2
    s_cbranch_scc1 K2_NOGW
    s_add_u32 m0, s7, 20480
    s_nop 0
    buffer_load_dwordx4 v10, s[28:31], s7 offen lds
K2_NOGW:
    s_add_u32 s7, s3, 4
    s_lshl_b32 s7, s7, 10
    s_add_u32 s50, s6, s7
    s_add_u32 m0, s7, 0
    s_nop 0
    buffer_load_dwordx4 v10, s[16:19], s50 offen lds
    s_add_u32 m0, s7, 10240
    s_nop 0
    buffer_load_dwordx4 v10, s[24:27], s50 offen lds
    s_cmp_ge_u32 s3, 2
    s_cbranch_scc1 K2_DMAD
    s_add_u32 s7, s3, 8
    s_lshl_b32 s7, s7, 10
    s_add_u32 s50, s6, s7
    s_add_u32 m0, s7, 0
    s_nop 0
    buffer_load_dwordx4 v10, s[16:19], s50 offen lds
    s_add_u32 m0, s7, 10240
    s_nop 0
    buffer_load_dwordx4 v10, s[24:27], s50 offen lds
K2_DMAD:
    v_mul_u32_u24 v1, 6554, v0
    v_lshrrev_b32 v1, 16, v1
    v_mul_u32_u24 v2, 10, v1
    v_sub_u32 v2, v0, v2
    s_mul_i32 s6, s4, 25600
    s_mul_i32 s7, s5, 160
    s_add_u32 s6, s6, s7
    v_lshlrev_b32 v3, 4, v2
    v_add_u32 v3, s6, v3
    s_mov_b32 s50, 0
    buffer_load_dwordx4 v[100:103], v3, s[12:15], s50 offen
    s_mov_b32 s50, 1280
    buffer_load_dwordx4 v[104:107], v3, s[12:15], s50 offen
    s_mov_b32 s50, 2560
    buffer_load_dwordx4 v[108:111], v3, s[12:15], s50 offen
    s_mov_b32 s50, 3840
    buffer_load_dwordx4 v[112:115], v3, s[12:15], s50 offen
    s_mov_b32 s50, 5120
    buffer_load_dwordx4 v[116:119], v3, s[12:15], s50 offen
    s_mov_b32 s50, 6400
    buffer_load_dwordx4 v[120:123], v3, s[12:15], s50 offen
    s_mov_b32 s50, 7680
    buffer_load_dwordx4 v[124:127], v3, s[12:15], s50 offen
    s_mov_b32 s50, 8960
    buffer_load_dwordx4 v[128:131], v3, s[12:15], s50 offen
    s_mov_b32 s50, 10240
    buffer_load_dwordx4 v[132:135], v3, s[12:15], s50 offen
    s_mov_b32 s50, 11520
    buffer_load_dwordx4 v[136:139], v3, s[12:15], s50 offen
    s_mov_b32 s50, 12800
    buffer_load_dwordx4 v[140:143], v3, s[12:15], s50 offen
    s_mov_b32 s50, 14080
    buffer_load_dwordx4 v[144:147], v3, s[12:15], s50 offen
    s_mov_b32 s50, 15360
    buffer_load_dwordx4 v[148:151], v3, s[12:15], s50 offen
    s_mov_b32 s50, 16640
    buffer_load_dwordx4 v[152:155], v3, s[12:15], s50 offen
    s_mov_b32 s50, 17920
    buffer_load_dwordx4 v[156:159], v3, s[12:15], s50 offen
    s_mov_b32 s50, 19200
    buffer_load_dwordx4 v[160:163], v3, s[12:15], s50 offen
    s_mov_b32 s50, 20480
    buffer_load_dwordx4 v[164:167], v3, s[12:15], s50 offen
    s_mov_b32 s50, 21760
    buffer_load_dwordx4 v[168:171], v3, s[12:15], s50 offen
    s_mov_b32 s50, 23040
    buffer_load_dwordx4 v[172:175], v3, s[12:15], s50 offen
    s_mov_b32 s50, 24320
    buffer_load_dwordx4 v[176:179], v3, s[12:15], s50 offen
    s_lshl_b32 s6, s2, 3
    v_add_u32 v8, 0, v0
    v_mul_u32_u24 v14, 820, v8
    v_lshrrev_b32 v14, 16, v14
    v_mul_u32_u24 v15, 80, v14
    v_sub_u32 v15, v8, v15
    v_add_u32 v14, s6, v14
    v_mul_u32_u24 v16, 1280, v14
    v_lshlrev_b32 v17, 4, v15
    v_add_u32 v16, v16, v17
    buffer_load_dwordx4 v[228:231], v16, s[88:91], 0 offen
    v_mul_u32_u24 v17, 6554, v15
    v_lshrrev_b32 v17, 16, v17
    v_mul_u32_u24 v18, 10, v17
    v_sub_u32 v18, v15, v18
    v_mul_u32_u24 v17, 54, v17
    v_lshrrev_b32 v19, 5, v14
    v_add_u32 v17, v17, v19
    v_mul_u32_u24 v17, 5120, v17
    v_and_b32 v19, 31, v14
    v_lshrrev_b32 v16, 3, v19
    v_and_b32 v16, 1, v16
    v_lshlrev_b32 v16, 2, v16
    v_xor_b32 v19, v19, v16
    v_mul_u32_u24 v19, 160, v19
    v_add_u32 v17, v17, v19
    v_lshlrev_b32 v18, 4, v18
    v_add_u32 v240, v17, v18
    v_add_u32 v8, 256, v0
    v_mul_u32_u24 v14, 820, v8
    v_lshrrev_b32 v14, 16, v14
    v_mul_u32_u24 v15, 80, v14
    v_sub_u32 v15, v8, v15
    v_add_u32 v14, s6, v14
    v_mul_u32_u24 v16, 1280, v14
    v_lshlrev_b32 v17, 4, v15
    v_add_u32 v16, v16, v17
    buffer_load_dwordx4 v[232:235], v16, s[88:91], 0 offen
    v_mul_u32_u24 v17, 6554, v15
    v_lshrrev_b32 v17, 16, v17
    v_mul_u32_u24 v18, 10, v17
    v_sub_u32 v18, v15, v18
    v_mul_u32_u24 v17, 54, v17
    v_lshrrev_b32 v19, 5, v14
    v_add_u32 v17, v17, v19
    v_mul_u32_u24 v17, 5120, v17
    v_and_b32 v19, 31, v14
    v_lshrrev_b32 v16, 3, v19
    v_and_b32 v16, 1, v16
    v_lshlrev_b32 v16, 2, v16
    v_xor_b32 v19, v19, v16
    v_mul_u32_u24 v19, 160, v19
    v_add_u32 v17, v17, v19
    v_lshlrev_b32 v18, 4, v18
    v_add_u32 v241, v17, v18
    v_add_u32 v8, 512, v0
    v_mul_u32_u24 v14, 820, v8
    v_lshrrev_b32 v14, 16, v14
    v_mul_u32_u24 v15, 80, v14
    v_sub_u32 v15, v8, v15
    v_add_u32 v14, s6, v14
    v_mul_u32_u24 v16, 1280, v14
    v_lshlrev_b32 v17, 4, v15
    v_add_u32 v16, v16, v17
    v_cmp_gt_u32 vcc, 128, v0
    s_nop 1
    v_cndmask_b32 v16, v12, v16, vcc
    buffer_load_dwordx4 v[236:239], v16, s[88:91], 0 offen
    v_mul_u32_u24 v17, 6554, v15
    v_lshrrev_b32 v17, 16, v17
    v_mul_u32_u24 v18, 10, v17
    v_sub_u32 v18, v15, v18
    v_mul_u32_u24 v17, 54, v17
    v_lshrrev_b32 v19, 5, v14
    v_add_u32 v17, v17, v19
    v_mul_u32_u24 v17, 5120, v17
    v_and_b32 v19, 31, v14
    v_lshrrev_b32 v16, 3, v19
    v_and_b32 v16, 1, v16
    v_lshlrev_b32 v16, 2, v16
    v_xor_b32 v19, v19, v16
    v_mul_u32_u24 v19, 160, v19
    v_add_u32 v17, v17, v19
    v_lshlrev_b32 v18, 4, v18
    v_add_u32 v242, v17, v18
    v_cndmask_b32 v242, v12, v242, vcc
    s_cmp_ge_u32 s2, 216
    s_cbranch_scc0 K2_W2OK
    v_mov_b32 v240, 0x7fffffff
    v_mov_b32 v241, 0x7fffffff
    v_mov_b32 v242, 0x7fffffff
K2_W2OK:
    s_waitcnt vmcnt(23)
    s_cmp_ge_u32 s3, 3
    s_cbranch_scc1 K2_NORED
    v_pk_add_f32 v[20:21], v[20:21], v[24:25]
    v_pk_add_f32 v[22:23], v[22:23], v[26:27]
    v_pk_add_f32 v[20:21], v[20:21], v[28:29]
    v_pk_add_f32 v[22:23], v[22:23], v[30:31]
    v_pk_add_f32 v[20:21], v[20:21], v[32:33]
    v_pk_add_f32 v[22:23], v[22:23], v[34:35]
    v_pk_add_f32 v[20:21], v[20:21], v[36:37]
    v_pk_add_f32 v[22:23], v[22:23], v[38:39]
    v_pk_add_f32 v[20:21], v[20:21], v[40:41]
    v_pk_add_f32 v[22:23], v[22:23], v[42:43]
    v_pk_add_f32 v[20:21], v[20:21], v[44:45]
    v_pk_add_f32 v[22:23], v[22:23], v[46:47]
    v_pk_add_f32 v[20:21], v[20:21], v[48:49]
    v_pk_add_f32 v[22:23], v[22:23], v[50:51]
    v_pk_add_f32 v[20:21], v[20:21], v[52:53]
    v_pk_add_f32 v[22:23], v[22:23], v[54:55]
    v_pk_add_f32 v[20:21], v[20:21], v[56:57]
    v_pk_add_f32 v[22:23], v[22:23], v[58:59]
    v_pk_add_f32 v[20:21], v[20:21], v[60:61]
    v_pk_add_f32 v[22:23], v[22:23], v[62:63]
    v_cvt_pk_bf16_f32 v64, v20, v21
    v_cvt_pk_bf16_f32 v65, v22, v23
    v_lshlrev_b32 v20, 16, v64
    v_and_b32 v21, 0xffff0000, v64
    v_lshlrev_b32 v22, 16, v65
    v_and_b32 v23, 0xffff0000, v65
    v_lshlrev_b32 v8, 4, v0
    v_min_u32 v8, 2544, v8
    v_cmp_gt_u32 vcc, 160, v0
    s_and_saveexec_b64 s[54:55], vcc
    ds_write_b128 v8, v[20:23] offset:22528
    s_mov_b64 exec, s[54:55]
    s_cmp_ge_u32 s3, 2
    s_cbranch_scc1 K2_NORED
    v_pk_add_f32 v[180:181], v[180:181], v[184:185]
    v_pk_add_f32 v[182:183], v[182:183], v[186:187]
    v_pk_add_f32 v[180:181], v[180:181], v[188:189]
    v_pk_add_f32 v[182:183], v[182:183], v[190:191]
    v_pk_add_f32 v[180:181], v[180:181], v[192:193]
    v_pk_add_f32 v[182:183], v[182:183], v[194:195]
    v_pk_add_f32 v[180:181], v[180:181], v[196:197]
    v_pk_add_f32 v[182:183], v[182:183], v[198:199]
    v_pk_add_f32 v[180:181], v[180:181], v[200:201]
    v_pk_add_f32 v[182:183], v[182:183], v[202:203]
    v_pk_add_f32 v[180:181], v[180:181], v[204:205]
    v_pk_add_f32 v[182:183], v[182:183], v[206:207]
    v_pk_add_f32 v[180:181], v[180:181], v[208:209]
    v_pk_add_f32 v[182:183], v[182:183], v[210:211]
    v_pk_add_f32 v[180:181], v[180:181], v[212:213]
    v_pk_add_f32 v[182:183], v[182:183], v[214:215]
    v_pk_add_f32 v[180:181], v[180:181], v[216:217]
    v_pk_add_f32 v[182:183], v[182:183], v[218:219]
    v_pk_add_f32 v[180:181], v[180:181], v[220:221]
    v_pk_add_f32 v[182:183], v[182:183], v[222:223]
    v_cvt_pk_bf16_f32 v64, v180, v181
    v_cvt_pk_bf16_f32 v65, v182, v183
    v_lshlrev_b32 v20, 16, v64
    v_and_b32 v21, 0xffff0000, v64
    v_lshlrev_b32 v22, 16, v65
    v_and_b32 v23, 0xffff0000, v65
    v_lshlrev_b32 v8, 4, v0
    ds_write_b128 v8, v[20:23] offset:25088
K2_NORED:
    s_waitcnt lgkmcnt(0)
    s_barrier
    v_lshrrev_b32 v4, 5, v0
    v_and_b32 v5, 31, v0
    v_mul_u32_u24 v6, 1280, v4
    v_mul_u32_u24 v7, 40, v5
    v_add_u32 v6, v6, v7
    ds_read_b64 v[20:21], v6 offset:0
    ds_read_b64 v[22:23], v6 offset:8
    ds_read_b64 v[24:25], v6 offset:16
    ds_read_b64 v[26:27], v6 offset:24
    ds_read_b64 v[28:29], v6 offset:32
    ds_read_b64 v[30:31], v6 offset:10240
    ds_read_b64 v[32:33], v6 offset:10248
    ds_read_b64 v[34:35], v6 offset:10256
    ds_read_b64 v[36:37], v6 offset:10264
    ds_read_b64 v[38:39], v6 offset:10272
    ds_read_b64 v[40:41], v7 offset:20480
    ds_read_b64 v[42:43], v7 offset:20488
    ds_read_b64 v[44:45], v7 offset:20496
    ds_read_b64 v[46:47], v7 offset:20504
    ds_read_b64 v[48:49], v7 offset:20512
    v_mul_u32_u24 v13, 80, v5
    ds_read_b128 v[60:63], v13 offset:22528
    ds_read_b128 v[64:67], v13 offset:22544
    ds_read_b128 v[68:71], v13 offset:22560
    ds_read_b128 v[72:75], v13 offset:22576
    ds_read_b128 v[76:79], v13 offset:22592
    s_waitcnt lgkmcnt(5)
    v_mov_b32 v84, 0
    v_mov_b32 v85, 0
    v_lshlrev_b32 v12, 16, v30
    v_lshlrev_b32 v14, 16, v40
    v_fmac_f32 v84, v12, v14
    v_and_b32 v12, 0xffff0000, v30
    v_and_b32 v14, 0xffff0000, v40
    v_fmac_f32 v85, v12, v14
    v_lshlrev_b32 v12, 16, v31
    v_lshlrev_b32 v14, 16, v41
    v_fmac_f32 v84, v12, v14
    v_and_b32 v12, 0xffff0000, v31
    v_and_b32 v14, 0xffff0000, v41
    v_fmac_f32 v85, v12, v14
    v_lshlrev_b32 v12, 16, v32
    v_lshlrev_b32 v14, 16, v42
    v_fmac_f32 v84, v12, v14
    v_and_b32 v12, 0xffff0000, v32
    v_and_b32 v14, 0xffff0000, v42
    v_fmac_f32 v85, v12, v14
    v_lshlrev_b32 v12, 16, v33
    v_lshlrev_b32 v14, 16, v43
    v_fmac_f32 v84, v12, v14
    v_and_b32 v12, 0xffff0000, v33
    v_and_b32 v14, 0xffff0000, v43
    v_fmac_f32 v85, v12, v14
    v_lshlrev_b32 v12, 16, v34
    v_lshlrev_b32 v14, 16, v44
    v_fmac_f32 v84, v12, v14
    v_and_b32 v12, 0xffff0000, v34
    v_and_b32 v14, 0xffff0000, v44
    v_fmac_f32 v85, v12, v14
    v_lshlrev_b32 v12, 16, v35
    v_lshlrev_b32 v14, 16, v45
    v_fmac_f32 v84, v12, v14
    v_and_b32 v12, 0xffff0000, v35
    v_and_b32 v14, 0xffff0000, v45
    v_fmac_f32 v85, v12, v14
    v_lshlrev_b32 v12, 16, v36
    v_lshlrev_b32 v14, 16, v46
    v_fmac_f32 v84, v12, v14
    v_and_b32 v12, 0xffff0000, v36
    v_and_b32 v14, 0xffff0000, v46
    v_fmac_f32 v85, v12, v14
    v_lshlrev_b32 v12, 16, v37
    v_lshlrev_b32 v14, 16, v47
    v_fmac_f32 v84, v12, v14
    v_and_b32 v12, 0xffff0000, v37
    v_and_b32 v14, 0xffff0000, v47
    v_fmac_f32 v85, v12, v14
    v_lshlrev_b32 v12, 16, v38
    v_lshlrev_b32 v14, 16, v48
    v_fmac_f32 v84, v12, v14
    v_and_b32 v12, 0xffff0000, v38
    v_and_b32 v14, 0xffff0000, v48
    v_fmac_f32 v85, v12, v14
    v_lshlrev_b32 v12, 16, v39
    v_lshlrev_b32 v14, 16, v49
    v_fmac_f32 v84, v12, v14
    v_and_b32 v12, 0xffff0000, v39
    v_and_b32 v14, 0xffff0000, v49
    v_fmac_f32 v85, v12, v14
    v_add_f32 v84, v84, v85
    v_lshlrev_b32 v204, 16, v20
    v_and_b32 v205, 0xffff0000, v20
    v_lshlrev_b32 v206, 16, v21
    v_and_b32 v207, 0xffff0000, v21
    v_lshlrev_b32 v208, 16, v22
    v_and_b32 v209, 0xffff0000, v22
    v_lshlrev_b32 v210, 16, v23
    v_and_b32 v211, 0xffff0000, v23
    v_lshlrev_b32 v212, 16, v24
    v_and_b32 v213, 0xffff0000, v24
    v_lshlrev_b32 v214, 16, v25
    v_and_b32 v215, 0xffff0000, v25
    v_lshlrev_b32 v216, 16, v26
    v_and_b32 v217, 0xffff0000, v26
    v_lshlrev_b32 v218, 16, v27
    v_and_b32 v219, 0xffff0000, v27
    v_lshlrev_b32 v220, 16, v28
    v_and_b32 v221, 0xffff0000, v28
    v_lshlrev_b32 v222, 16, v29
    v_and_b32 v223, 0xffff0000, v29
    s_waitcnt lgkmcnt(0)
    v_mov_b32 v86, 0
    v_mov_b32 v87, 0
    v_fmac_f32 v86, v204, v60
    v_fmac_f32 v87, v205, v61
    v_fmac_f32 v86, v206, v62
    v_fmac_f32 v87, v207, v63
    v_fmac_f32 v86, v208, v64
    v_fmac_f32 v87, v209, v65
    v_fmac_f32 v86, v210, v66
    v_fmac_f32 v87, v211, v67
    v_fmac_f32 v86, v212, v68
    v_fmac_f32 v87, v213, v69
    v_fmac_f32 v86, v214, v70
    v_fmac_f32 v87, v215, v71
    v_fmac_f32 v86, v216, v72
    v_fmac_f32 v87, v217, v73
    v_fmac_f32 v86, v218, v74
    v_fmac_f32 v87, v219, v75
    v_fmac_f32 v86, v220, v76
    v_fmac_f32 v87, v221, v77
    v_fmac_f32 v86, v222, v78
    v_fmac_f32 v87, v223, v79
    v_add_f32 v86, v86, v87
    ds_swizzle_b32 v12, v84 offset:1055
    s_waitcnt lgkmcnt(0)
    v_add_f32 v84, v84, v12
    ds_swizzle_b32 v12, v84 offset:2079
    s_waitcnt lgkmcnt(0)
    v_add_f32 v84, v84, v12
    ds_swizzle_b32 v12, v84 offset:4127
    s_waitcnt lgkmcnt(0)
    v_add_f32 v84, v84, v12
    ds_swizzle_b32 v12, v84 offset:8223
    s_waitcnt lgkmcnt(0)
    v_add_f32 v84, v84, v12
    ds_swizzle_b32 v12, v84 offset:16415
    s_waitcnt lgkmcnt(0)
    v_add_f32 v84, v84, v12
    v_cvt_pk_bf16_f32 v12, v84, v84
    v_lshlrev_b32 v12, 16, v12
    s_mov_b32 s50, 3216550459
    s_mov_b32 s51, 897988541
    v_mul_f32 v12, s50, v12
    v_exp_f32 v12, v12
    v_add_f32 v86, s51, v86
    v_add_f32 v12, 1.0, v12
    v_rcp_f32 v85, v12
    v_rcp_f32 v86, v86
    s_nop 0
    v_mul_f32 v86, v86, v85
    v_mov_b32 v87, v86
    v_pk_mul_f32 v[204:205], v[204:205], v[86:87]
    v_pk_mul_f32 v[206:207], v[206:207], v[86:87]
    v_pk_mul_f32 v[208:209], v[208:209], v[86:87]
    v_pk_mul_f32 v[210:211], v[210:211], v[86:87]
    v_pk_mul_f32 v[212:213], v[212:213], v[86:87]
    v_pk_mul_f32 v[214:215], v[214:215], v[86:87]
    v_pk_mul_f32 v[216:217], v[216:217], v[86:87]
    v_pk_mul_f32 v[218:219], v[218:219], v[86:87]
    v_pk_mul_f32 v[220:221], v[220:221], v[86:87]
    v_pk_mul_f32 v[222:223], v[222:223], v[86:87]
    v_cvt_pk_bf16_f32 v20, v204, v205
    v_cvt_pk_bf16_f32 v21, v206, v207
    v_cvt_pk_bf16_f32 v22, v208, v209
    v_cvt_pk_bf16_f32 v23, v210, v211
    v_cvt_pk_bf16_f32 v24, v212, v213
    v_cvt_pk_bf16_f32 v25, v214, v215
    v_cvt_pk_bf16_f32 v26, v216, v217
    v_cvt_pk_bf16_f32 v27, v218, v219
    v_cvt_pk_bf16_f32 v28, v220, v221
    v_cvt_pk_bf16_f32 v29, v222, v223
    ds_write_b64 v6, v[20:21] offset:27136
    ds_write_b64 v6, v[22:23] offset:27144
    ds_write_b64 v6, v[24:25] offset:27152
    ds_write_b64 v6, v[26:27] offset:27160
    ds_write_b64 v6, v[28:29] offset:27168
    s_lshl_b32 s6, s2, 3
    v_add_u32 v4, s6, v4
    v_sub_f32 v12, 1.0, v85
    v_lshlrev_b32 v13, 2, v4
    v_cmp_eq_u32 vcc, 0, v5
    v_mov_b32 v14, 0x7fffffff
    s_nop 1
    v_cndmask_b32 v13, v14, v13, vcc
    buffer_store_dword v12, v13, s[36:39], 0 offen
    v_mul_u32_u24 v13, 80, v1
    ds_read_b128 v[60:63], v13 offset:25088
    ds_read_b128 v[64:67], v13 offset:25104
    ds_read_b128 v[68:71], v13 offset:25120
    ds_read_b128 v[72:75], v13 offset:25136
    ds_read_b128 v[76:79], v13 offset:25152
    s_waitcnt lgkmcnt(0)
    s_barrier
    s_lshl_b32 s6, s2, 3
    v_add_u32 v8, 0, v0
    v_mul_u32_u24 v14, 820, v8
    v_lshrrev_b32 v14, 16, v14
    v_mul_u32_u24 v15, 80, v14
    v_sub_u32 v15, v8, v15
    v_lshlrev_b32 v16, 4, v8
    v_min_u32 v16, 10224, v16
    ds_read_b128 v[24:27], v16 offset:27136
    v_add_u32 v14, s6, v14
    v_and_b32 v17, 63, v14
    v_lshrrev_b32 v18, 2, v17
    v_sub_u32 v18, 0, v18
    v_and_b32 v18, 3, v18
    v_and_b32 v19, 3, v15
    v_xor_b32 v18, v18, v19
    v_lshlrev_b32 v18, 4, v18
    v_lshlrev_b32 v17, 6, v17
    v_add_u32 v17, v17, v18
    v_lshrrev_b32 v14, 6, v14
    v_mul_u32_u24 v14, 20, v14
    v_lshrrev_b32 v15, 2, v15
    v_add_u32 v14, v14, v15
    v_lshlrev_b32 v14, 12, v14
    v_add_u32 v36, v14, v17
    v_add_u32 v8, 256, v0
    v_mul_u32_u24 v14, 820, v8
    v_lshrrev_b32 v14, 16, v14
    v_mul_u32_u24 v15, 80, v14
    v_sub_u32 v15, v8, v15
    v_lshlrev_b32 v16, 4, v8
    v_min_u32 v16, 10224, v16
    ds_read_b128 v[28:31], v16 offset:27136
    v_add_u32 v14, s6, v14
    v_and_b32 v17, 63, v14
    v_lshrrev_b32 v18, 2, v17
    v_sub_u32 v18, 0, v18
    v_and_b32 v18, 3, v18
    v_and_b32 v19, 3, v15
    v_xor_b32 v18, v18, v19
    v_lshlrev_b32 v18, 4, v18
    v_lshlrev_b32 v17, 6, v17
    v_add_u32 v17, v17, v18
    v_lshrrev_b32 v14, 6, v14
    v_mul_u32_u24 v14, 20, v14
    v_lshrrev_b32 v15, 2, v15
    v_add_u32 v14, v14, v15
    v_lshlrev_b32 v14, 12, v14
    v_add_u32 v37, v14, v17
    v_add_u32 v8, 512, v0
    v_mul_u32_u24 v14, 820, v8
    v_lshrrev_b32 v14, 16, v14
    v_mul_u32_u24 v15, 80, v14
    v_sub_u32 v15, v8, v15
    v_lshlrev_b32 v16, 4, v8
    v_min_u32 v16, 10224, v16
    ds_read_b128 v[32:35], v16 offset:27136
    v_add_u32 v14, s6, v14
    v_and_b32 v17, 63, v14
    v_lshrrev_b32 v18, 2, v17
    v_sub_u32 v18, 0, v18
    v_and_b32 v18, 3, v18
    v_and_b32 v19, 3, v15
    v_xor_b32 v18, v18, v19
    v_lshlrev_b32 v18, 4, v18
    v_lshlrev_b32 v17, 6, v17
    v_add_u32 v17, v17, v18
    v_lshrrev_b32 v14, 6, v14
    v_mul_u32_u24 v14, 20, v14
    v_lshrrev_b32 v15, 2, v15
    v_add_u32 v14, v14, v15
    v_lshlrev_b32 v14, 12, v14
    v_add_u32 v38, v14, v17
    v_cmp_gt_u32 vcc, 128, v0
    v_mov_b32 v14, 0x7fffffff
    s_nop 1
    v_cndmask_b32 v38, v14, v38, vcc
    s_waitcnt lgkmcnt(0)
    buffer_store_dwordx4 v[24:27], v36, s[20:23], 0 offen
    buffer_store_dwordx4 v[28:31], v37, s[20:23], 0 offen
    buffer_store_dwordx4 v[32:35], v38, s[20:23], 0 offen
    v_mov_b32 v204, 0
    v_mov_b32 v205, 0
    v_mov_b32 v206, 0
    v_mov_b32 v207, 0
    v_mov_b32 v208, 0
    v_mov_b32 v209, 0
    v_mov_b32 v210, 0
    v_mov_b32 v211, 0
    s_waitcnt vmcnt(7)
    v_lshlrev_b32 v12, 16, v100
    v_and_b32 v14, 0xffff0000, v100
    v_fmac_f32 v204, v60, v12
    v_fmac_f32 v205, v60, v14
    v_lshlrev_b32 v12, 16, v101
    v_and_b32 v14, 0xffff0000, v101
    v_fmac_f32 v206, v60, v12
    v_fmac_f32 v207, v60, v14
    v_lshlrev_b32 v12, 16, v102
    v_and_b32 v14, 0xffff0000, v102
    v_fmac_f32 v208, v60, v12
    v_fmac_f32 v209, v60, v14
    v_lshlrev_b32 v12, 16, v103
    v_and_b32 v14, 0xffff0000, v103
    v_fmac_f32 v210, v60, v12
    v_fmac_f32 v211, v60, v14
    v_lshlrev_b32 v12, 16, v104
    v_and_b32 v14, 0xffff0000, v104
    v_fmac_f32 v204, v61, v12
    v_fmac_f32 v205, v61, v14
    v_lshlrev_b32 v12, 16, v105
    v_and_b32 v14, 0xffff0000, v105
    v_fmac_f32 v206, v61, v12
    v_fmac_f32 v207, v61, v14
    v_lshlrev_b32 v12, 16, v106
    v_and_b32 v14, 0xffff0000, v106
    v_fmac_f32 v208, v61, v12
    v_fmac_f32 v209, v61, v14
    v_lshlrev_b32 v12, 16, v107
    v_and_b32 v14, 0xffff0000, v107
    v_fmac_f32 v210, v61, v12
    v_fmac_f32 v211, v61, v14
    v_lshlrev_b32 v12, 16, v108
    v_and_b32 v14, 0xffff0000, v108
    v_fmac_f32 v204, v62, v12
    v_fmac_f32 v205, v62, v14
    v_lshlrev_b32 v12, 16, v109
    v_and_b32 v14, 0xffff0000, v109
    v_fmac_f32 v206, v62, v12
    v_fmac_f32 v207, v62, v14
    v_lshlrev_b32 v12, 16, v110
    v_and_b32 v14, 0xffff0000, v110
    v_fmac_f32 v208, v62, v12
    v_fmac_f32 v209, v62, v14
    v_lshlrev_b32 v12, 16, v111
    v_and_b32 v14, 0xffff0000, v111
    v_fmac_f32 v210, v62, v12
    v_fmac_f32 v211, v62, v14
    v_lshlrev_b32 v12, 16, v112
    v_and_b32 v14, 0xffff0000, v112
    v_fmac_f32 v204, v63, v12
    v_fmac_f32 v205, v63, v14
    v_lshlrev_b32 v12, 16, v113
    v_and_b32 v14, 0xffff0000, v113
    v_fmac_f32 v206, v63, v12
    v_fmac_f32 v207, v63, v14
    v_lshlrev_b32 v12, 16, v114
    v_and_b32 v14, 0xffff0000, v114
    v_fmac_f32 v208, v63, v12
    v_fmac_f32 v209, v63, v14
    v_lshlrev_b32 v12, 16, v115
    v_and_b32 v14, 0xffff0000, v115
    v_fmac_f32 v210, v63, v12
    v_fmac_f32 v211, v63, v14
    v_lshlrev_b32 v12, 16, v116
    v_and_b32 v14, 0xffff0000, v116
    v_fmac_f32 v204, v64, v12
    v_fmac_f32 v205, v64, v14
    v_lshlrev_b32 v12, 16, v117
    v_and_b32 v14, 0xffff0000, v117
    v_fmac_f32 v206, v64, v12
    v_fmac_f32 v207, v64, v14
    v_lshlrev_b32 v12, 16, v118
    v_and_b32 v14, 0xffff0000, v118
    v_fmac_f32 v208, v64, v12
    v_fmac_f32 v209, v64, v14
    v_lshlrev_b32 v12, 16, v119
    v_and_b32 v14, 0xffff0000, v119
    v_fmac_f32 v210, v64, v12
    v_fmac_f32 v211, v64, v14
    v_lshlrev_b32 v12, 16, v120
    v_and_b32 v14, 0xffff0000, v120
    v_fmac_f32 v204, v65, v12
    v_fmac_f32 v205, v65, v14
    v_lshlrev_b32 v12, 16, v121
    v_and_b32 v14, 0xffff0000, v121
    v_fmac_f32 v206, v65, v12
    v_fmac_f32 v207, v65, v14
    v_lshlrev_b32 v12, 16, v122
    v_and_b32 v14, 0xffff0000, v122
    v_fmac_f32 v208, v65, v12
    v_fmac_f32 v209, v65, v14
    v_lshlrev_b32 v12, 16, v123
    v_and_b32 v14, 0xffff0000, v123
    v_fmac_f32 v210, v65, v12
    v_fmac_f32 v211, v65, v14
    v_lshlrev_b32 v12, 16, v124
    v_and_b32 v14, 0xffff0000, v124
    v_fmac_f32 v204, v66, v12
    v_fmac_f32 v205, v66, v14
    v_lshlrev_b32 v12, 16, v125
    v_and_b32 v14, 0xffff0000, v125
    v_fmac_f32 v206, v66, v12
    v_fmac_f32 v207, v66, v14
    v_lshlrev_b32 v12, 16, v126
    v_and_b32 v14, 0xffff0000, v126
    v_fmac_f32 v208, v66, v12
    v_fmac_f32 v209, v66, v14
    v_lshlrev_b32 v12, 16, v127
    v_and_b32 v14, 0xffff0000, v127
    v_fmac_f32 v210, v66, v12
    v_fmac_f32 v211, v66, v14
    v_lshlrev_b32 v12, 16, v128
    v_and_b32 v14, 0xffff0000, v128
    v_fmac_f32 v204, v67, v12
    v_fmac_f32 v205, v67, v14
    v_lshlrev_b32 v12, 16, v129
    v_and_b32 v14, 0xffff0000, v129
    v_fmac_f32 v206, v67, v12
    v_fmac_f32 v207, v67, v14
    v_lshlrev_b32 v12, 16, v130
    v_and_b32 v14, 0xffff0000, v130
    v_fmac_f32 v208, v67, v12
    v_fmac_f32 v209, v67, v14
    v_lshlrev_b32 v12, 16, v131
    v_and_b32 v14, 0xffff0000, v131
    v_fmac_f32 v210, v67, v12
    v_fmac_f32 v211, v67, v14
    v_lshlrev_b32 v12, 16, v132
    v_and_b32 v14, 0xffff0000, v132
    v_fmac_f32 v204, v68, v12
    v_fmac_f32 v205, v68, v14
    v_lshlrev_b32 v12, 16, v133
    v_and_b32 v14, 0xffff0000, v133
    v_fmac_f32 v206, v68, v12
    v_fmac_f32 v207, v68, v14
    v_lshlrev_b32 v12, 16, v134
    v_and_b32 v14, 0xffff0000, v134
    v_fmac_f32 v208, v68, v12
    v_fmac_f32 v209, v68, v14
    v_lshlrev_b32 v12, 16, v135
    v_and_b32 v14, 0xffff0000, v135
    v_fmac_f32 v210, v68, v12
    v_fmac_f32 v211, v68, v14
    v_lshlrev_b32 v12, 16, v136
    v_and_b32 v14, 0xffff0000, v136
    v_fmac_f32 v204, v69, v12
    v_fmac_f32 v205, v69, v14
    v_lshlrev_b32 v12, 16, v137
    v_and_b32 v14, 0xffff0000, v137
    v_fmac_f32 v206, v69, v12
    v_fmac_f32 v207, v69, v14
    v_lshlrev_b32 v12, 16, v138
    v_and_b32 v14, 0xffff0000, v138
    v_fmac_f32 v208, v69, v12
    v_fmac_f32 v209, v69, v14
    v_lshlrev_b32 v12, 16, v139
    v_and_b32 v14, 0xffff0000, v139
    v_fmac_f32 v210, v69, v12
    v_fmac_f32 v211, v69, v14
    v_lshlrev_b32 v12, 16, v140
    v_and_b32 v14, 0xffff0000, v140
    v_fmac_f32 v204, v70, v12
    v_fmac_f32 v205, v70, v14
    v_lshlrev_b32 v12, 16, v141
    v_and_b32 v14, 0xffff0000, v141
    v_fmac_f32 v206, v70, v12
    v_fmac_f32 v207, v70, v14
    v_lshlrev_b32 v12, 16, v142
    v_and_b32 v14, 0xffff0000, v142
    v_fmac_f32 v208, v70, v12
    v_fmac_f32 v209, v70, v14
    v_lshlrev_b32 v12, 16, v143
    v_and_b32 v14, 0xffff0000, v143
    v_fmac_f32 v210, v70, v12
    v_fmac_f32 v211, v70, v14
    v_lshlrev_b32 v12, 16, v144
    v_and_b32 v14, 0xffff0000, v144
    v_fmac_f32 v204, v71, v12
    v_fmac_f32 v205, v71, v14
    v_lshlrev_b32 v12, 16, v145
    v_and_b32 v14, 0xffff0000, v145
    v_fmac_f32 v206, v71, v12
    v_fmac_f32 v207, v71, v14
    v_lshlrev_b32 v12, 16, v146
    v_and_b32 v14, 0xffff0000, v146
    v_fmac_f32 v208, v71, v12
    v_fmac_f32 v209, v71, v14
    v_lshlrev_b32 v12, 16, v147
    v_and_b32 v14, 0xffff0000, v147
    v_fmac_f32 v210, v71, v12
    v_fmac_f32 v211, v71, v14
    v_lshlrev_b32 v12, 16, v148
    v_and_b32 v14, 0xffff0000, v148
    v_fmac_f32 v204, v72, v12
    v_fmac_f32 v205, v72, v14
    v_lshlrev_b32 v12, 16, v149
    v_and_b32 v14, 0xffff0000, v149
    v_fmac_f32 v206, v72, v12
    v_fmac_f32 v207, v72, v14
    v_lshlrev_b32 v12, 16, v150
    v_and_b32 v14, 0xffff0000, v150
    v_fmac_f32 v208, v72, v12
    v_fmac_f32 v209, v72, v14
    v_lshlrev_b32 v12, 16, v151
    v_and_b32 v14, 0xffff0000, v151
    v_fmac_f32 v210, v72, v12
    v_fmac_f32 v211, v72, v14
    v_lshlrev_b32 v12, 16, v152
    v_and_b32 v14, 0xffff0000, v152
    v_fmac_f32 v204, v73, v12
    v_fmac_f32 v205, v73, v14
    v_lshlrev_b32 v12, 16, v153
    v_and_b32 v14, 0xffff0000, v153
    v_fmac_f32 v206, v73, v12
    v_fmac_f32 v207, v73, v14
    v_lshlrev_b32 v12, 16, v154
    v_and_b32 v14, 0xffff0000, v154
    v_fmac_f32 v208, v73, v12
    v_fmac_f32 v209, v73, v14
    v_lshlrev_b32 v12, 16, v155
    v_and_b32 v14, 0xffff0000, v155
    v_fmac_f32 v210, v73, v12
    v_fmac_f32 v211, v73, v14
    v_lshlrev_b32 v12, 16, v156
    v_and_b32 v14, 0xffff0000, v156
    v_fmac_f32 v204, v74, v12
    v_fmac_f32 v205, v74, v14
    v_lshlrev_b32 v12, 16, v157
    v_and_b32 v14, 0xffff0000, v157
    v_fmac_f32 v206, v74, v12
    v_fmac_f32 v207, v74, v14
    v_lshlrev_b32 v12, 16, v158
    v_and_b32 v14, 0xffff0000, v158
    v_fmac_f32 v208, v74, v12
    v_fmac_f32 v209, v74, v14
    v_lshlrev_b32 v12, 16, v159
    v_and_b32 v14, 0xffff0000, v159
    v_fmac_f32 v210, v74, v12
    v_fmac_f32 v211, v74, v14
    v_lshlrev_b32 v12, 16, v160
    v_and_b32 v14, 0xffff0000, v160
    v_fmac_f32 v204, v75, v12
    v_fmac_f32 v205, v75, v14
    v_lshlrev_b32 v12, 16, v161
    v_and_b32 v14, 0xffff0000, v161
    v_fmac_f32 v206, v75, v12
    v_fmac_f32 v207, v75, v14
    v_lshlrev_b32 v12, 16, v162
    v_and_b32 v14, 0xffff0000, v162
    v_fmac_f32 v208, v75, v12
    v_fmac_f32 v209, v75, v14
    v_lshlrev_b32 v12, 16, v163
    v_and_b32 v14, 0xffff0000, v163
    v_fmac_f32 v210, v75, v12
    v_fmac_f32 v211, v75, v14
    v_lshlrev_b32 v12, 16, v164
    v_and_b32 v14, 0xffff0000, v164
    v_fmac_f32 v204, v76, v12
    v_fmac_f32 v205, v76, v14
    v_lshlrev_b32 v12, 16, v165
    v_and_b32 v14, 0xffff0000, v165
    v_fmac_f32 v206, v76, v12
    v_fmac_f32 v207, v76, v14
    v_lshlrev_b32 v12, 16, v166
    v_and_b32 v14, 0xffff0000, v166
    v_fmac_f32 v208, v76, v12
    v_fmac_f32 v209, v76, v14
    v_lshlrev_b32 v12, 16, v167
    v_and_b32 v14, 0xffff0000, v167
    v_fmac_f32 v210, v76, v12
    v_fmac_f32 v211, v76, v14
    v_lshlrev_b32 v12, 16, v168
    v_and_b32 v14, 0xffff0000, v168
    v_fmac_f32 v204, v77, v12
    v_fmac_f32 v205, v77, v14
    v_lshlrev_b32 v12, 16, v169
    v_and_b32 v14, 0xffff0000, v169
    v_fmac_f32 v206, v77, v12
    v_fmac_f32 v207, v77, v14
    v_lshlrev_b32 v12, 16, v170
    v_and_b32 v14, 0xffff0000, v170
    v_fmac_f32 v208, v77, v12
    v_fmac_f32 v209, v77, v14
    v_lshlrev_b32 v12, 16, v171
    v_and_b32 v14, 0xffff0000, v171
    v_fmac_f32 v210, v77, v12
    v_fmac_f32 v211, v77, v14
    v_lshlrev_b32 v12, 16, v172
    v_and_b32 v14, 0xffff0000, v172
    v_fmac_f32 v204, v78, v12
    v_fmac_f32 v205, v78, v14
    v_lshlrev_b32 v12, 16, v173
    v_and_b32 v14, 0xffff0000, v173
    v_fmac_f32 v206, v78, v12
    v_fmac_f32 v207, v78, v14
    v_lshlrev_b32 v12, 16, v174
    v_and_b32 v14, 0xffff0000, v174
    v_fmac_f32 v208, v78, v12
    v_fmac_f32 v209, v78, v14
    v_lshlrev_b32 v12, 16, v175
    v_and_b32 v14, 0xffff0000, v175
    v_fmac_f32 v210, v78, v12
    v_fmac_f32 v211, v78, v14
    v_lshlrev_b32 v12, 16, v176
    v_and_b32 v14, 0xffff0000, v176
    v_fmac_f32 v204, v79, v12
    v_fmac_f32 v205, v79, v14
    v_lshlrev_b32 v12, 16, v177
    v_and_b32 v14, 0xffff0000, v177
    v_fmac_f32 v206, v79, v12
    v_fmac_f32 v207, v79, v14
    v_lshlrev_b32 v12, 16, v178
    v_and_b32 v14, 0xffff0000, v178
    v_fmac_f32 v208, v79, v12
    v_fmac_f32 v209, v79, v14
    v_lshlrev_b32 v12, 16, v179
    v_and_b32 v14, 0xffff0000, v179
    v_fmac_f32 v210, v79, v12
    v_fmac_f32 v211, v79, v14
    v_cvt_pk_bf16_f32 v216, v204, v205
    v_cvt_pk_bf16_f32 v217, v206, v207
    v_cvt_pk_bf16_f32 v218, v208, v209
    v_cvt_pk_bf16_f32 v219, v210, v211
    s_mul_i32 s6, s4, 20
    v_add_u32 v13, s6, v1
    v_lshrrev_b32 v12, 5, v13
    s_mul_i32 s7, s5, 20
    v_add_u32 v12, s7, v12
    v_mul_u32_u24 v12, 5120, v12
    v_and_b32 v13, 31, v13
    v_lshrrev_b32 v15, 3, v13
    v_and_b32 v15, 1, v15
    v_lshlrev_b32 v15, 2, v15
    v_xor_b32 v13, v13, v15
    v_mul_u32_u24 v13, 160, v13
    v_add_u32 v13, v13, v12
    v_lshlrev_b32 v12, 4, v2
    v_add_u32 v13, v13, v12
    v_cmp_gt_u32 vcc, 200, v0
    v_mov_b32 v14, 0x7fffffff
    s_nop 1
    v_cndmask_b32 v13, v14, v13, vcc
    buffer_store_dwordx4 v[216:219], v13, s[32:35], 0 offen
    s_waitcnt vmcnt(5)
    buffer_store_dwordx4 v[228:231], v240, s[84:87], 0 offen
    buffer_store_dwordx4 v[232:235], v241, s[84:87], 0 offen
    buffer_store_dwordx4 v[236:239], v242, s[84:87], 0 offen
K2_END:
K2_EXIT:
    s_endpgm
.section .rodata,"a"
.p2align 6
.amdhsa_kernel k2_small_kernel
  .amdhsa_next_free_vgpr 244
  .amdhsa_next_free_sgpr 102
  .amdhsa_accum_offset 244
  .amdhsa_group_segment_fixed_size 0
  .amdhsa_kernarg_size 96
  .amdhsa_user_sgpr_count 2
  .amdhsa_user_sgpr_kernarg_segment_ptr 1
  .amdhsa_system_sgpr_workgroup_id_x 1
.end_amdhsa_kernel
.text
.globl gated_mix__linear_attn_block__dense_activation_gelu__prompt_kernel
.p2align 8
.type gated_mix__linear_attn_block__dense_activation_gelu__prompt_kernel,@function
gated_mix__linear_attn_block__dense_activation_gelu__prompt_kernel:
    s_cmp_ge_u32 s2, 256
    s_cbranch_scc1 K3_EXIT
    s_load_dwordx4 s[36:39], s[0:1], 48
    s_load_dwordx2 s[40:41], s[0:1], 72
    s_load_dwordx2 s[42:43], s[0:1], 88
    s_and_b32 s3, s2, 7
    s_lshl_b32 s3, s3, 2
    s_lshr_b32 s31, s2, 3
    s_and_b32 s32, s31, 3
    s_add_u32 s4, s3, s32
    s_lshr_b32 s5, s2, 5
    v_lshrrev_b32 v1, 6, v0
    v_and_b32 v2, 63, v0
    s_nop 0
    v_readfirstlane_b32 s7, v1
    v_lshrrev_b32 v3, 4, v2
    v_and_b32 v4, 15, v2
    s_waitcnt lgkmcnt(0)
    s_mov_b32 s16, s40
    s_and_b32 s17, s41, 0xffff
    s_mov_b32 s18, 2621440
    s_mov_b32 s19, 0x00020000
    s_mov_b32 s20, s38
    s_and_b32 s21, s39, 0xffff
    s_mov_b32 s22, 1280
    s_mov_b32 s23, 0x00020000
    s_add_u32 s44, s42, 13139968
    s_addc_u32 s45, s43, 0
    s_mov_b32 s24, s44
    s_and_b32 s25, s45, 0xffff
    s_mov_b32 s26, 8192
    s_mov_b32 s27, 0x00020000
    s_cmp_eq_u32 s7, 3
    s_cbranch_scc1 K3_SET_ATT
    s_add_u32 s44, s42, 0
    s_addc_u32 s45, s43, 0
    s_mov_b32 s8, s44
    s_and_b32 s9, s45, 0xffff
    s_mov_b32 s10, 7077888
    s_mov_b32 s11, 0x00020000
    s_add_u32 s44, s42, 13762560
    s_addc_u32 s45, s43, 0
    s_mov_b32 s12, s44
    s_and_b32 s13, s45, 0xffff
    s_mov_b32 s14, 2211840
    s_mov_b32 s15, 0x00020000
    s_mul_i32 s28, s4, 54
    s_mul_i32 s29, s5, 54
    s_mul_i32 s31, s7, 18
    s_add_u32 s28, s28, s31
    s_add_u32 s29, s29, s31
    s_branch K3_SET_DONE
K3_SET_ATT:
    s_add_u32 s44, s42, 9699328
    s_addc_u32 s45, s43, 0
    s_mov_b32 s8, s44
    s_and_b32 s9, s45, 0xffff
    s_mov_b32 s10, 2621440
    s_mov_b32 s11, 0x00020000
    s_add_u32 s44, s42, 12320768
    s_addc_u32 s45, s43, 0
    s_mov_b32 s12, s44
    s_and_b32 s13, s45, 0xffff
    s_mov_b32 s14, 819200
    s_mov_b32 s15, 0x00020000
    s_mul_i32 s28, s4, 20
    s_mul_i32 s29, s5, 20
K3_SET_DONE:
    s_lshl_b32 s28, s28, 12
    s_mul_i32 s29, s29, 5120
    s_mul_i32 s30, s7, 36864
    s_lshl_b32 s31, s4, 6
    s_lshl_b32 s32, s7, 4
    s_add_u32 s31, s31, s32
    v_add_u32 v5, s31, v4
    v_lshlrev_b32 v1, 2, v5
    buffer_load_dword v110, v1, s[24:27], 0 offen
    s_mul_i32 s32, s5, 160
    v_lshlrev_b32 v1, 3, v3
    v_add_u32 v1, s32, v1
    buffer_load_dwordx2 v[112:113], v1, s[20:23], 0 offen offset:0
    buffer_load_dwordx2 v[114:115], v1, s[20:23], 0 offen offset:32
    buffer_load_dwordx2 v[116:117], v1, s[20:23], 0 offen offset:64
    buffer_load_dwordx2 v[118:119], v1, s[20:23], 0 offen offset:96
    buffer_load_dwordx2 v[120:121], v1, s[20:23], 0 offen offset:128
    v_mul_u32_u24 v111, 1280, v5
    v_add_u32 v111, v111, v1
    v_lshlrev_b32 v6, 4, v2
    v_add_u32 v7, 4096, v6
    v_lshrrev_b32 v1, 2, v4
    v_sub_u32 v18, 0, v1
    v_and_b32 v18, 3, v18
    v_xor_b32 v18, v18, v3
    v_lshlrev_b32 v18, 4, v18
    v_lshlrev_b32 v15, 6, v4
    v_add_u32 v15, v15, v18
    v_add_u32 v15, s30, v15
    v_lshlrev_b32 v18, 3, v3
    v_add_u32 v18, v18, v1
    v_and_b32 v19, 1, v3
    v_lshlrev_b32 v19, 2, v19
    v_add_u32 v20, v18, v19
    v_xor_b32 v19, 4, v19
    v_add_u32 v21, v18, v19
    v_and_b32 v19, 3, v2
    v_lshlrev_b32 v19, 3, v19
    s_add_u32 s31, s30, 4096
    v_mul_u32_u24 v16, 160, v20
    v_add_u32 v16, v16, v19
    v_add_u32 v16, s31, v16
    v_mul_u32_u24 v17, 160, v21
    v_add_u32 v17, v17, v19
    v_add_u32 v17, s31, v17
    v_mov_b32 v128, 0
    v_mov_b32 v129, 0
    v_mov_b32 v130, 0
    v_mov_b32 v131, 0
    v_mov_b32 v132, 0
    v_mov_b32 v133, 0
    v_mov_b32 v134, 0
    v_mov_b32 v135, 0
    v_mov_b32 v136, 0
    v_mov_b32 v137, 0
    v_mov_b32 v138, 0
    v_mov_b32 v139, 0
    v_mov_b32 v140, 0
    v_mov_b32 v141, 0
    v_mov_b32 v142, 0
    v_mov_b32 v143, 0
    v_mov_b32 v144, 0
    v_mov_b32 v145, 0
    v_mov_b32 v146, 0
    v_mov_b32 v147, 0
    v_mov_b32 v148, 0
    v_mov_b32 v149, 0
    v_mov_b32 v150, 0
    v_mov_b32 v151, 0
    v_mov_b32 v152, 0
    v_mov_b32 v153, 0
    v_mov_b32 v154, 0
    v_mov_b32 v155, 0
    v_mov_b32 v156, 0
    v_mov_b32 v157, 0
    v_mov_b32 v158, 0
    v_mov_b32 v159, 0
    v_mov_b32 v160, 0
    v_mov_b32 v161, 0
    v_mov_b32 v162, 0
    v_mov_b32 v163, 0
    v_mov_b32 v164, 0
    v_mov_b32 v165, 0
    v_mov_b32 v166, 0
    v_mov_b32 v167, 0
    v_mov_b32 v168, 0
    v_mov_b32 v169, 0
    v_mov_b32 v170, 0
    v_mov_b32 v171, 0
    v_mov_b32 v172, 0
    v_mov_b32 v173, 0
    v_mov_b32 v174, 0
    v_mov_b32 v175, 0
    v_mov_b32 v176, 0
    v_mov_b32 v177, 0
    v_mov_b32 v178, 0
    v_mov_b32 v179, 0
    v_mov_b32 v180, 0
    v_mov_b32 v181, 0
    v_mov_b32 v182, 0
    v_mov_b32 v183, 0
    v_mov_b32 v184, 0
    v_mov_b32 v185, 0
    v_mov_b32 v186, 0
    v_mov_b32 v187, 0
    v_mov_b32 v188, 0
    v_mov_b32 v189, 0
    v_mov_b32 v190, 0
    v_mov_b32 v191, 0
    v_mov_b32 v192, 0
    v_mov_b32 v193, 0
    v_mov_b32 v194, 0
    v_mov_b32 v195, 0
    v_mov_b32 v196, 0
    v_mov_b32 v197, 0
    v_mov_b32 v198, 0
    v_mov_b32 v199, 0
    v_mov_b32 v200, 0
    v_mov_b32 v201, 0
    v_mov_b32 v202, 0
    v_mov_b32 v203, 0
    v_mov_b32 v204, 0
    v_mov_b32 v205, 0
    v_mov_b32 v206, 0
    v_mov_b32 v207, 0
    s_cmp_eq_u32 s7, 3
    s_cselect_b32 s50, 20, 18
    s_mov_b32 s52, 27648
    s_sub_u32 s28, s28, 4096
    s_sub_u32 s29, s29, 5120
    s_mov_b32 s53, 0
    s_add_u32 s28, s28, 4096
    s_add_u32 s29, s29, 5120
    s_add_u32 s52, s52, 9216
    s_cmp_eq_u32 s52, 36864
    s_cselect_b32 s52, 0, s52
    s_add_u32 s88, s30, s52
    s_add_u32 s89, s88, 4096
    s_add_u32 s90, s88, 8192
    s_mov_b32 m0, s88
    s_nop 0
    buffer_load_dwordx4 v6, s[8:11], s28 offen offset:0 lds
    buffer_load_dwordx4 v6, s[8:11], s28 offen offset:1024 lds
    buffer_load_dwordx4 v6, s[8:11], s28 offen offset:2048 lds
    buffer_load_dwordx4 v6, s[8:11], s28 offen offset:3072 lds
    s_mov_b32 m0, s89
    s_nop 0
    buffer_load_dwordx4 v6, s[12:15], s29 offen offset:0 lds
    buffer_load_dwordx4 v6, s[12:15], s29 offen offset:1024 lds
    buffer_load_dwordx4 v6, s[12:15], s29 offen offset:2048 lds
    buffer_load_dwordx4 v6, s[12:15], s29 offen offset:3072 lds
    s_mov_b32 m0, s90
    s_nop 0
    buffer_load_dwordx4 v7, s[12:15], s29 offen lds
    s_add_u32 s28, s28, 4096
    s_add_u32 s29, s29, 5120
    s_add_u32 s52, s52, 9216
    s_cmp_eq_u32 s52, 36864
    s_cselect_b32 s52, 0, s52
    s_add_u32 s88, s30, s52
    s_add_u32 s89, s88, 4096
    s_add_u32 s90, s88, 8192
    s_mov_b32 m0, s88
    s_nop 0
    buffer_load_dwordx4 v6, s[8:11], s28 offen offset:0 lds
    buffer_load_dwordx4 v6, s[8:11], s28 offen offset:1024 lds
    buffer_load_dwordx4 v6, s[8:11], s28 offen offset:2048 lds
    buffer_load_dwordx4 v6, s[8:11], s28 offen offset:3072 lds
    s_mov_b32 m0, s89
    s_nop 0
    buffer_load_dwordx4 v6, s[12:15], s29 offen offset:0 lds
    buffer_load_dwordx4 v6, s[12:15], s29 offen offset:1024 lds
    buffer_load_dwordx4 v6, s[12:15], s29 offen offset:2048 lds
    buffer_load_dwordx4 v6, s[12:15], s29 offen offset:3072 lds
    s_mov_b32 m0, s90
    s_nop 0
    buffer_load_dwordx4 v7, s[12:15], s29 offen lds
    s_add_u32 s28, s28, 4096
    s_add_u32 s29, s29, 5120
    s_add_u32 s52, s52, 9216
    s_cmp_eq_u32 s52, 36864
    s_cselect_b32 s52, 0, s52
    s_add_u32 s88, s30, s52
    s_add_u32 s89, s88, 4096
    s_add_u32 s90, s88, 8192
    s_mov_b32 m0, s88
    s_nop 0
    buffer_load_dwordx4 v6, s[8:11], s28 offen offset:0 lds
    buffer_load_dwordx4 v6, s[8:11], s28 offen offset:1024 lds
    buffer_load_dwordx4 v6, s[8:11], s28 offen offset:2048 lds
    buffer_load_dwordx4 v6, s[8:11], s28 offen offset:3072 lds
    s_mov_b32 m0, s89
    s_nop 0
    buffer_load_dwordx4 v6, s[12:15], s29 offen offset:0 lds
    buffer_load_dwordx4 v6, s[12:15], s29 offen offset:1024 lds
    buffer_load_dwordx4 v6, s[12:15], s29 offen offset:2048 lds
    buffer_load_dwordx4 v6, s[12:15], s29 offen offset:3072 lds
    s_mov_b32 m0, s90
    s_nop 0
    buffer_load_dwordx4 v7, s[12:15], s29 offen lds
    s_add_u32 s28, s28, 4096
    s_add_u32 s29, s29, 5120
    s_add_u32 s52, s52, 9216
    s_cmp_eq_u32 s52, 36864
    s_cselect_b32 s52, 0, s52
    s_add_u32 s88, s30, s52
    s_add_u32 s89, s88, 4096
    s_add_u32 s90, s88, 8192
    s_mov_b32 m0, s88
    s_nop 0
    buffer_load_dwordx4 v6, s[8:11], s28 offen offset:0 lds
    buffer_load_dwordx4 v6, s[8:11], s28 offen offset:1024 lds
    buffer_load_dwordx4 v6, s[8:11], s28 offen offset:2048 lds
    buffer_load_dwordx4 v6, s[8:11], s28 offen offset:3072 lds
    s_mov_b32 m0, s89
    s_nop 0
    buffer_load_dwordx4 v6, s[12:15], s29 offen offset:0 lds
    buffer_load_dwordx4 v6, s[12:15], s29 offen offset:1024 lds
    buffer_load_dwordx4 v6, s[12:15], s29 offen offset:2048 lds
    buffer_load_dwordx4 v6, s[12:15], s29 offen offset:3072 lds
    s_mov_b32 m0, s90
    s_nop 0
    buffer_load_dwordx4 v7, s[12:15], s29 offen lds
    s_waitcnt vmcnt(27)
    ds_read_b128 v[22:25], v15 offset:0
    ds_read_b128 v[26:29], v15 offset:1024
    ds_read_b128 v[30:33], v15 offset:2048
    ds_read_b128 v[34:37], v15 offset:3072
    ds_read_b64_tr_b16 v[38:39], v16 offset:0
    ds_read_b64_tr_b16 v[40:41], v17 offset:0
    ds_read_b64_tr_b16 v[42:43], v16 offset:32
    ds_read_b64_tr_b16 v[44:45], v17 offset:32
    ds_read_b64_tr_b16 v[46:47], v16 offset:64
    ds_read_b64_tr_b16 v[48:49], v17 offset:64
    ds_read_b64_tr_b16 v[50:51], v16 offset:96
    ds_read_b64_tr_b16 v[52:53], v17 offset:96
    ds_read_b64_tr_b16 v[54:55], v16 offset:128
    ds_read_b64_tr_b16 v[56:57], v17 offset:128
    s_mov_b32 s51, 0
K3_LOOP:
    s_waitcnt lgkmcnt(0)
    s_add_u32 s32, s51, 4
    s_cmp_lt_u32 s32, s50
    s_cbranch_scc0 K3_TAIL0
    s_add_u32 s28, s28, 4096
    s_add_u32 s29, s29, 5120
    s_add_u32 s52, s52, 9216
    s_cmp_eq_u32 s52, 36864
    s_cselect_b32 s52, 0, s52
    s_add_u32 s88, s30, s52
    s_add_u32 s89, s88, 4096
    s_add_u32 s90, s88, 8192
    s_add_u32 s53, s53, 1
    s_cmp_eq_u32 s53, 4
    s_cselect_b32 s53, 0, s53
    s_mov_b32 s31, 9216
    s_cselect_b32 s31, 4294939648, s31
    v_add_u32 v15, s31, v15
    v_add_u32 v16, s31, v16
    v_add_u32 v17, s31, v17
    s_waitcnt vmcnt(18)
    s_cmp_eq_u32 s51, s51
    s_branch K3_BODY0
K3_TAIL0:
    s_add_u32 s32, s51, 1
    s_cmp_ge_u32 s32, s50
    s_cbranch_scc1 K3_FIN0
    s_add_u32 s53, s53, 1
    s_cmp_eq_u32 s53, 4
    s_cselect_b32 s53, 0, s53
    s_mov_b32 s31, 9216
    s_cselect_b32 s31, 4294939648, s31
    v_add_u32 v15, s31, v15
    v_add_u32 v16, s31, v16
    v_add_u32 v17, s31, v17
    s_waitcnt vmcnt(0)
    s_cmp_lg_u32 s51, s51
K3_BODY0:
    v_mfma_f32_16x16x32_bf16 v[128:131], v[38:41], v[22:25], v[128:131]
    ds_read_b128 v[58:61], v15 offset:0
    v_mfma_f32_16x16x32_bf16 v[148:151], v[38:41], v[26:29], v[148:151]
    ds_read_b128 v[62:65], v15 offset:1024
    s_cbranch_scc0 K3_SK0_0
    s_mov_b32 m0, s88
    s_nop 0
    buffer_load_dwordx4 v6, s[8:11], s28 offen offset:0 lds
K3_SK0_0:
    v_mfma_f32_16x16x32_bf16 v[168:171], v[38:41], v[30:33], v[168:171]
    ds_read_b128 v[66:69], v15 offset:2048
    v_mfma_f32_16x16x32_bf16 v[188:191], v[38:41], v[34:37], v[188:191]
    ds_read_b128 v[70:73], v15 offset:3072
    s_cbranch_scc0 K3_SK0_1
    buffer_load_dwordx4 v6, s[8:11], s28 offen offset:1024 lds
K3_SK0_1:
    v_mfma_f32_16x16x32_bf16 v[132:135], v[42:45], v[22:25], v[132:135]
    ds_read_b64_tr_b16 v[74:75], v16 offset:0
    v_mfma_f32_16x16x32_bf16 v[152:155], v[42:45], v[26:29], v[152:155]
    ds_read_b64_tr_b16 v[76:77], v17 offset:0
    s_cbranch_scc0 K3_SK0_2
    buffer_load_dwordx4 v6, s[8:11], s28 offen offset:2048 lds
K3_SK0_2:
    v_mfma_f32_16x16x32_bf16 v[172:175], v[42:45], v[30:33], v[172:175]
    ds_read_b64_tr_b16 v[78:79], v16 offset:32
    v_mfma_f32_16x16x32_bf16 v[192:195], v[42:45], v[34:37], v[192:195]
    ds_read_b64_tr_b16 v[80:81], v17 offset:32
    s_cbranch_scc0 K3_SK0_3
    buffer_load_dwordx4 v6, s[8:11], s28 offen offset:3072 lds
K3_SK0_3:
    v_mfma_f32_16x16x32_bf16 v[136:139], v[46:49], v[22:25], v[136:139]
    ds_read_b64_tr_b16 v[82:83], v16 offset:64
    v_mfma_f32_16x16x32_bf16 v[156:159], v[46:49], v[26:29], v[156:159]
    ds_read_b64_tr_b16 v[84:85], v17 offset:64
    s_cbranch_scc0 K3_SK0_4
    s_mov_b32 m0, s89
    s_nop 0
    buffer_load_dwordx4 v6, s[12:15], s29 offen offset:0 lds
K3_SK0_4:
    v_mfma_f32_16x16x32_bf16 v[176:179], v[46:49], v[30:33], v[176:179]
    ds_read_b64_tr_b16 v[86:87], v16 offset:96
    v_mfma_f32_16x16x32_bf16 v[196:199], v[46:49], v[34:37], v[196:199]
    ds_read_b64_tr_b16 v[88:89], v17 offset:96
    s_cbranch_scc0 K3_SK0_5
    buffer_load_dwordx4 v6, s[12:15], s29 offen offset:1024 lds
K3_SK0_5:
    v_mfma_f32_16x16x32_bf16 v[140:143], v[50:53], v[22:25], v[140:143]
    ds_read_b64_tr_b16 v[90:91], v16 offset:128
    v_mfma_f32_16x16x32_bf16 v[160:163], v[50:53], v[26:29], v[160:163]
    ds_read_b64_tr_b16 v[92:93], v17 offset:128
    s_cbranch_scc0 K3_SK0_6
    buffer_load_dwordx4 v6, s[12:15], s29 offen offset:2048 lds
K3_SK0_6:
    v_mfma_f32_16x16x32_bf16 v[180:183], v[50:53], v[30:33], v[180:183]
    v_mfma_f32_16x16x32_bf16 v[200:203], v[50:53], v[34:37], v[200:203]
    s_cbranch_scc0 K3_SK0_7
    buffer_load_dwordx4 v6, s[12:15], s29 offen offset:3072 lds
K3_SK0_7:
    v_mfma_f32_16x16x32_bf16 v[144:147], v[54:57], v[22:25], v[144:147]
    v_mfma_f32_16x16x32_bf16 v[164:167], v[54:57], v[26:29], v[164:167]
    s_cbranch_scc0 K3_SK0_8
    s_mov_b32 m0, s90
    s_nop 0
    buffer_load_dwordx4 v7, s[12:15], s29 offen lds
K3_SK0_8:
    v_mfma_f32_16x16x32_bf16 v[184:187], v[54:57], v[30:33], v[184:187]
    v_mfma_f32_16x16x32_bf16 v[204:207], v[54:57], v[34:37], v[204:207]
    s_add_u32 s51, s51, 1
    s_waitcnt lgkmcnt(0)
    s_add_u32 s32, s51, 4
    s_cmp_lt_u32 s32, s50
    s_cbranch_scc0 K3_TAIL1
    s_add_u32 s28, s28, 4096
    s_add_u32 s29, s29, 5120
    s_add_u32 s52, s52, 9216
    s_cmp_eq_u32 s52, 36864
    s_cselect_b32 s52, 0, s52
    s_add_u32 s88, s30, s52
    s_add_u32 s89, s88, 4096
    s_add_u32 s90, s88, 8192
    s_add_u32 s53, s53, 1
    s_cmp_eq_u32 s53, 4
    s_cselect_b32 s53, 0, s53
    s_mov_b32 s31, 9216
    s_cselect_b32 s31, 4294939648, s31
    v_add_u32 v15, s31, v15
    v_add_u32 v16, s31, v16
    v_add_u32 v17, s31, v17
    s_waitcnt vmcnt(18)
    s_cmp_eq_u32 s51, s51
    s_branch K3_BODY1
K3_TAIL1:
    s_add_u32 s32, s51, 1
    s_cmp_ge_u32 s32, s50
    s_cbranch_scc1 K3_FIN1
    s_add_u32 s53, s53, 1
    s_cmp_eq_u32 s53, 4
    s_cselect_b32 s53, 0, s53
    s_mov_b32 s31, 9216
    s_cselect_b32 s31, 4294939648, s31
    v_add_u32 v15, s31, v15
    v_add_u32 v16, s31, v16
    v_add_u32 v17, s31, v17
    s_waitcnt vmcnt(0)
    s_cmp_lg_u32 s51, s51
K3_BODY1:
    v_mfma_f32_16x16x32_bf16 v[128:131], v[74:77], v[58:61], v[128:131]
    ds_read_b128 v[22:25], v15 offset:0
    v_mfma_f32_16x16x32_bf16 v[148:151], v[74:77], v[62:65], v[148:151]
    ds_read_b128 v[26:29], v15 offset:1024
    s_cbranch_scc0 K3_SK1_0
    s_mov_b32 m0, s88
    s_nop 0
    buffer_load_dwordx4 v6, s[8:11], s28 offen offset:0 lds
K3_SK1_0:
    v_mfma_f32_16x16x32_bf16 v[168:171], v[74:77], v[66:69], v[168:171]
    ds_read_b128 v[30:33], v15 offset:2048
    v_mfma_f32_16x16x32_bf16 v[188:191], v[74:77], v[70:73], v[188:191]
    ds_read_b128 v[34:37], v15 offset:3072
    s_cbranch_scc0 K3_SK1_1
    buffer_load_dwordx4 v6, s[8:11], s28 offen offset:1024 lds
K3_SK1_1:
    v_mfma_f32_16x16x32_bf16 v[132:135], v[78:81], v[58:61], v[132:135]
    ds_read_b64_tr_b16 v[38:39], v16 offset:0
    v_mfma_f32_16x16x32_bf16 v[152:155], v[78:81], v[62:65], v[152:155]
    ds_read_b64_tr_b16 v[40:41], v17 offset:0
    s_cbranch_scc0 K3_SK1_2
    buffer_load_dwordx4 v6, s[8:11], s28 offen offset:2048 lds
K3_SK1_2:
    v_mfma_f32_16x16x32_bf16 v[172:175], v[78:81], v[66:69], v[172:175]
    ds_read_b64_tr_b16 v[42:43], v16 offset:32
    v_mfma_f32_16x16x32_bf16 v[192:195], v[78:81], v[70:73], v[192:195]
    ds_read_b64_tr_b16 v[44:45], v17 offset:32
    s_cbranch_scc0 K3_SK1_3
    buffer_load_dwordx4 v6, s[8:11], s28 offen offset:3072 lds
K3_SK1_3:
    v_mfma_f32_16x16x32_bf16 v[136:139], v[82:85], v[58:61], v[136:139]
    ds_read_b64_tr_b16 v[46:47], v16 offset:64
    v_mfma_f32_16x16x32_bf16 v[156:159], v[82:85], v[62:65], v[156:159]
    ds_read_b64_tr_b16 v[48:49], v17 offset:64
    s_cbranch_scc0 K3_SK1_4
    s_mov_b32 m0, s89
    s_nop 0
    buffer_load_dwordx4 v6, s[12:15], s29 offen offset:0 lds
K3_SK1_4:
    v_mfma_f32_16x16x32_bf16 v[176:179], v[82:85], v[66:69], v[176:179]
    ds_read_b64_tr_b16 v[50:51], v16 offset:96
    v_mfma_f32_16x16x32_bf16 v[196:199], v[82:85], v[70:73], v[196:199]
    ds_read_b64_tr_b16 v[52:53], v17 offset:96
    s_cbranch_scc0 K3_SK1_5
    buffer_load_dwordx4 v6, s[12:15], s29 offen offset:1024 lds
K3_SK1_5:
    v_mfma_f32_16x16x32_bf16 v[140:143], v[86:89], v[58:61], v[140:143]
    ds_read_b64_tr_b16 v[54:55], v16 offset:128
    v_mfma_f32_16x16x32_bf16 v[160:163], v[86:89], v[62:65], v[160:163]
    ds_read_b64_tr_b16 v[56:57], v17 offset:128
    s_cbranch_scc0 K3_SK1_6
    buffer_load_dwordx4 v6, s[12:15], s29 offen offset:2048 lds
K3_SK1_6:
    v_mfma_f32_16x16x32_bf16 v[180:183], v[86:89], v[66:69], v[180:183]
    v_mfma_f32_16x16x32_bf16 v[200:203], v[86:89], v[70:73], v[200:203]
    s_cbranch_scc0 K3_SK1_7
    buffer_load_dwordx4 v6, s[12:15], s29 offen offset:3072 lds
K3_SK1_7:
    v_mfma_f32_16x16x32_bf16 v[144:147], v[90:93], v[58:61], v[144:147]
    v_mfma_f32_16x16x32_bf16 v[164:167], v[90:93], v[62:65], v[164:167]
    s_cbranch_scc0 K3_SK1_8
    s_mov_b32 m0, s90
    s_nop 0
    buffer_load_dwordx4 v7, s[12:15], s29 offen lds
K3_SK1_8:
    v_mfma_f32_16x16x32_bf16 v[184:187], v[90:93], v[66:69], v[184:187]
    v_mfma_f32_16x16x32_bf16 v[204:207], v[90:93], v[70:73], v[204:207]
    s_add_u32 s51, s51, 1
    s_branch K3_LOOP
K3_FIN0:
    v_mfma_f32_16x16x32_bf16 v[128:131], v[38:41], v[22:25], v[128:131]
    v_mfma_f32_16x16x32_bf16 v[148:151], v[38:41], v[26:29], v[148:151]
    v_mfma_f32_16x16x32_bf16 v[168:171], v[38:41], v[30:33], v[168:171]
    v_mfma_f32_16x16x32_bf16 v[188:191], v[38:41], v[34:37], v[188:191]
    v_mfma_f32_16x16x32_bf16 v[132:135], v[42:45], v[22:25], v[132:135]
    v_mfma_f32_16x16x32_bf16 v[152:155], v[42:45], v[26:29], v[152:155]
    v_mfma_f32_16x16x32_bf16 v[172:175], v[42:45], v[30:33], v[172:175]
    v_mfma_f32_16x16x32_bf16 v[192:195], v[42:45], v[34:37], v[192:195]
    v_mfma_f32_16x16x32_bf16 v[136:139], v[46:49], v[22:25], v[136:139]
    v_mfma_f32_16x16x32_bf16 v[156:159], v[46:49], v[26:29], v[156:159]
    v_mfma_f32_16x16x32_bf16 v[176:179], v[46:49], v[30:33], v[176:179]
    v_mfma_f32_16x16x32_bf16 v[196:199], v[46:49], v[34:37], v[196:199]
    v_mfma_f32_16x16x32_bf16 v[140:143], v[50:53], v[22:25], v[140:143]
    v_mfma_f32_16x16x32_bf16 v[160:163], v[50:53], v[26:29], v[160:163]
    v_mfma_f32_16x16x32_bf16 v[180:183], v[50:53], v[30:33], v[180:183]
    v_mfma_f32_16x16x32_bf16 v[200:203], v[50:53], v[34:37], v[200:203]
    v_mfma_f32_16x16x32_bf16 v[144:147], v[54:57], v[22:25], v[144:147]
    v_mfma_f32_16x16x32_bf16 v[164:167], v[54:57], v[26:29], v[164:167]
    v_mfma_f32_16x16x32_bf16 v[184:187], v[54:57], v[30:33], v[184:187]
    v_mfma_f32_16x16x32_bf16 v[204:207], v[54:57], v[34:37], v[204:207]
    s_branch K3_DONE
K3_FIN1:
    v_mfma_f32_16x16x32_bf16 v[128:131], v[74:77], v[58:61], v[128:131]
    v_mfma_f32_16x16x32_bf16 v[148:151], v[74:77], v[62:65], v[148:151]
    v_mfma_f32_16x16x32_bf16 v[168:171], v[74:77], v[66:69], v[168:171]
    v_mfma_f32_16x16x32_bf16 v[188:191], v[74:77], v[70:73], v[188:191]
    v_mfma_f32_16x16x32_bf16 v[132:135], v[78:81], v[58:61], v[132:135]
    v_mfma_f32_16x16x32_bf16 v[152:155], v[78:81], v[62:65], v[152:155]
    v_mfma_f32_16x16x32_bf16 v[172:175], v[78:81], v[66:69], v[172:175]
    v_mfma_f32_16x16x32_bf16 v[192:195], v[78:81], v[70:73], v[192:195]
    v_mfma_f32_16x16x32_bf16 v[136:139], v[82:85], v[58:61], v[136:139]
    v_mfma_f32_16x16x32_bf16 v[156:159], v[82:85], v[62:65], v[156:159]
    v_mfma_f32_16x16x32_bf16 v[176:179], v[82:85], v[66:69], v[176:179]
    v_mfma_f32_16x16x32_bf16 v[196:199], v[82:85], v[70:73], v[196:199]
    v_mfma_f32_16x16x32_bf16 v[140:143], v[86:89], v[58:61], v[140:143]
    v_mfma_f32_16x16x32_bf16 v[160:163], v[86:89], v[62:65], v[160:163]
    v_mfma_f32_16x16x32_bf16 v[180:183], v[86:89], v[66:69], v[180:183]
    v_mfma_f32_16x16x32_bf16 v[200:203], v[86:89], v[70:73], v[200:203]
    v_mfma_f32_16x16x32_bf16 v[144:147], v[90:93], v[58:61], v[144:147]
    v_mfma_f32_16x16x32_bf16 v[164:167], v[90:93], v[62:65], v[164:167]
    v_mfma_f32_16x16x32_bf16 v[184:187], v[90:93], v[66:69], v[184:187]
    v_mfma_f32_16x16x32_bf16 v[204:207], v[90:93], v[70:73], v[204:207]
K3_DONE:
    s_nop 7
    s_nop 7
    s_barrier
    s_mul_i32 s31, s7, 20480
    v_lshlrev_b32 v1, 4, v2
    v_add_u32 v5, s31, v1
    ds_write_b128 v5, v[128:131] offset:0
    ds_write_b128 v5, v[132:135] offset:1024
    ds_write_b128 v5, v[136:139] offset:2048
    ds_write_b128 v5, v[140:143] offset:3072
    ds_write_b128 v5, v[144:147] offset:4096
    ds_write_b128 v5, v[148:151] offset:5120
    ds_write_b128 v5, v[152:155] offset:6144
    ds_write_b128 v5, v[156:159] offset:7168
    ds_write_b128 v5, v[160:163] offset:8192
    ds_write_b128 v5, v[164:167] offset:9216
    ds_write_b128 v5, v[168:171] offset:10240
    ds_write_b128 v5, v[172:175] offset:11264
    ds_write_b128 v5, v[176:179] offset:12288
    ds_write_b128 v5, v[180:183] offset:13312
    ds_write_b128 v5, v[184:187] offset:14336
    ds_write_b128 v5, v[188:191] offset:15360
    ds_write_b128 v5, v[192:195] offset:16384
    ds_write_b128 v5, v[196:199] offset:17408
    ds_write_b128 v5, v[200:203] offset:18432
    ds_write_b128 v5, v[204:207] offset:19456
    s_waitcnt lgkmcnt(0)
    s_barrier
    s_mul_i32 s31, s7, 5120
    v_add_u32 v5, s31, v1
    v_add_u32 v6, 40960, v5
    ds_read_b128 v[22:25], v5 offset:0
    ds_read_b128 v[26:29], v5 offset:20480
    ds_read_b128 v[30:33], v6 offset:0
    ds_read_b128 v[34:37], v6 offset:20480
    ds_read_b128 v[38:41], v5 offset:1024
    ds_read_b128 v[42:45], v5 offset:21504
    ds_read_b128 v[46:49], v6 offset:1024
    ds_read_b128 v[50:53], v6 offset:21504
    ds_read_b128 v[54:57], v5 offset:2048
    ds_read_b128 v[58:61], v5 offset:22528
    ds_read_b128 v[62:65], v6 offset:2048
    ds_read_b128 v[66:69], v6 offset:22528
    ds_read_b128 v[70:73], v5 offset:3072
    ds_read_b128 v[74:77], v5 offset:23552
    ds_read_b128 v[78:81], v6 offset:3072
    ds_read_b128 v[82:85], v6 offset:23552
    ds_read_b128 v[86:89], v5 offset:4096
    ds_read_b128 v[90:93], v5 offset:24576
    ds_read_b128 v[94:97], v6 offset:4096
    ds_read_b128 v[98:101], v6 offset:24576
    s_waitcnt vmcnt(0) lgkmcnt(0)
    v_add_f32 v22, v22, v26
    v_add_f32 v23, v23, v27
    v_add_f32 v24, v24, v28
    v_add_f32 v25, v25, v29
    v_add_f32 v22, v22, v30
    v_add_f32 v23, v23, v31
    v_add_f32 v24, v24, v32
    v_add_f32 v25, v25, v33
    v_lshlrev_b32 v26, 16, v112
    v_and_b32 v27, 0xffff0000, v112
    v_lshlrev_b32 v28, 16, v113
    v_and_b32 v29, 0xffff0000, v113
    v_add_f32 v22, v22, v26
    v_add_f32 v23, v23, v27
    v_add_f32 v24, v24, v28
    v_add_f32 v25, v25, v29
    v_fma_f32 v22, v22, v110, v34
    v_fma_f32 v23, v23, v110, v35
    v_fma_f32 v24, v24, v110, v36
    v_fma_f32 v25, v25, v110, v37
    v_cvt_pk_bf16_f32 v30, v22, v23
    v_cvt_pk_bf16_f32 v31, v24, v25
    buffer_store_dwordx2 v[30:31], v111, s[16:19], 0 offen offset:0
    v_add_f32 v38, v38, v42
    v_add_f32 v39, v39, v43
    v_add_f32 v40, v40, v44
    v_add_f32 v41, v41, v45
    v_add_f32 v38, v38, v46
    v_add_f32 v39, v39, v47
    v_add_f32 v40, v40, v48
    v_add_f32 v41, v41, v49
    v_lshlrev_b32 v42, 16, v114
    v_and_b32 v43, 0xffff0000, v114
    v_lshlrev_b32 v44, 16, v115
    v_and_b32 v45, 0xffff0000, v115
    v_add_f32 v38, v38, v42
    v_add_f32 v39, v39, v43
    v_add_f32 v40, v40, v44
    v_add_f32 v41, v41, v45
    v_fma_f32 v38, v38, v110, v50
    v_fma_f32 v39, v39, v110, v51
    v_fma_f32 v40, v40, v110, v52
    v_fma_f32 v41, v41, v110, v53
    v_cvt_pk_bf16_f32 v46, v38, v39
    v_cvt_pk_bf16_f32 v47, v40, v41
    buffer_store_dwordx2 v[46:47], v111, s[16:19], 0 offen offset:32
    v_add_f32 v54, v54, v58
    v_add_f32 v55, v55, v59
    v_add_f32 v56, v56, v60
    v_add_f32 v57, v57, v61
    v_add_f32 v54, v54, v62
    v_add_f32 v55, v55, v63
    v_add_f32 v56, v56, v64
    v_add_f32 v57, v57, v65
    v_lshlrev_b32 v58, 16, v116
    v_and_b32 v59, 0xffff0000, v116
    v_lshlrev_b32 v60, 16, v117
    v_and_b32 v61, 0xffff0000, v117
    v_add_f32 v54, v54, v58
    v_add_f32 v55, v55, v59
    v_add_f32 v56, v56, v60
    v_add_f32 v57, v57, v61
    v_fma_f32 v54, v54, v110, v66
    v_fma_f32 v55, v55, v110, v67
    v_fma_f32 v56, v56, v110, v68
    v_fma_f32 v57, v57, v110, v69
    v_cvt_pk_bf16_f32 v62, v54, v55
    v_cvt_pk_bf16_f32 v63, v56, v57
    buffer_store_dwordx2 v[62:63], v111, s[16:19], 0 offen offset:64
    v_add_f32 v70, v70, v74
    v_add_f32 v71, v71, v75
    v_add_f32 v72, v72, v76
    v_add_f32 v73, v73, v77
    v_add_f32 v70, v70, v78
    v_add_f32 v71, v71, v79
    v_add_f32 v72, v72, v80
    v_add_f32 v73, v73, v81
    v_lshlrev_b32 v74, 16, v118
    v_and_b32 v75, 0xffff0000, v118
    v_lshlrev_b32 v76, 16, v119
    v_and_b32 v77, 0xffff0000, v119
    v_add_f32 v70, v70, v74
    v_add_f32 v71, v71, v75
    v_add_f32 v72, v72, v76
    v_add_f32 v73, v73, v77
    v_fma_f32 v70, v70, v110, v82
    v_fma_f32 v71, v71, v110, v83
    v_fma_f32 v72, v72, v110, v84
    v_fma_f32 v73, v73, v110, v85
    v_cvt_pk_bf16_f32 v78, v70, v71
    v_cvt_pk_bf16_f32 v79, v72, v73
    buffer_store_dwordx2 v[78:79], v111, s[16:19], 0 offen offset:96
    v_add_f32 v86, v86, v90
    v_add_f32 v87, v87, v91
    v_add_f32 v88, v88, v92
    v_add_f32 v89, v89, v93
    v_add_f32 v86, v86, v94
    v_add_f32 v87, v87, v95
    v_add_f32 v88, v88, v96
    v_add_f32 v89, v89, v97
    v_lshlrev_b32 v90, 16, v120
    v_and_b32 v91, 0xffff0000, v120
    v_lshlrev_b32 v92, 16, v121
    v_and_b32 v93, 0xffff0000, v121
    v_add_f32 v86, v86, v90
    v_add_f32 v87, v87, v91
    v_add_f32 v88, v88, v92
    v_add_f32 v89, v89, v93
    v_fma_f32 v86, v86, v110, v98
    v_fma_f32 v87, v87, v110, v99
    v_fma_f32 v88, v88, v110, v100
    v_fma_f32 v89, v89, v110, v101
    v_cvt_pk_bf16_f32 v94, v86, v87
    v_cvt_pk_bf16_f32 v95, v88, v89
    buffer_store_dwordx2 v[94:95], v111, s[16:19], 0 offen offset:128
K3_END:
K3_EXIT:
    s_endpgm
.section .rodata,"a"
.p2align 6
.amdhsa_kernel gated_mix__linear_attn_block__dense_activation_gelu__prompt_kernel
  .amdhsa_next_free_vgpr 208
  .amdhsa_next_free_sgpr 102
  .amdhsa_accum_offset 208
  .amdhsa_group_segment_fixed_size 0
  .amdhsa_kernarg_size 96
  .amdhsa_user_sgpr_count 2
  .amdhsa_user_sgpr_kernarg_segment_ptr 1
  .amdhsa_system_sgpr_workgroup_id_x 1
.end_amdhsa_kernel
.text
```
